```python
import torch

def _softmax(x, axis=-1):
    return torch.softmax(x, dim=axis)
def _gelu(x):
    return torch.nn.functional.gelu(x, approximate="tanh")
def _silu(x):
    return torch.nn.functional.silu(x)
def _sigmoid(x):
    return torch.sigmoid(x)
def _layernorm(x, axis=-1, eps=1e-5):
    m = x.mean(dim=axis, keepdim=True)
    v = x.var(dim=axis, keepdim=True, unbiased=False)
    return (x - m) / torch.sqrt(v + eps)
def _scatter_add(tgt, idx, src, axis=0):
    return tgt.clone().index_add_(axis, idx, src)
def _segment_sum(src, seg, n):
    out = torch.zeros((n,) + src.shape[1:], dtype=src.dtype)
    return out.index_add_(0, seg, src)
def _pad(x, pw):
    flat = tuple(v for pair in reversed(pw) for v in pair)
    return torch.nn.functional.pad(x, flat)

kernel_name = 'interleave_layers__linear_attn_block__glu_gated_bilinear__prompt'

def setup_inputs():

    _w = (lambda a: (lambda t: t.to(torch.bfloat16) if t.is_floating_point() else t)(torch.as_tensor(a)))
    def _A_setup():
        B, S, D = 1, 2048, 640
        return {
            "x": _w((lambda *s: torch.randn(*s, dtype=torch.bfloat16) * 0.05)(B, S, D)),
            "wqkv": _w((lambda *s: torch.randn(*s, dtype=torch.bfloat16) * 0.05)(D, 3 * D)),
            "wo": _w((lambda *s: torch.randn(*s, dtype=torch.bfloat16) * 0.05)(D, D)),
        }
    _A_in = _A_setup()

    def _B_setup():
        B, S, D, F = 1, 2048, 640, 1728
        return {
            "x": _w((lambda *s: torch.randn(*s, dtype=torch.bfloat16) * 0.05)(B, S, D)),
            "w_gate": _w((lambda *s: torch.randn(*s, dtype=torch.bfloat16) * 0.8)(D, F) * (D ** -0.5)),
            "w_up": _w((lambda *s: torch.randn(*s, dtype=torch.bfloat16) * 0.8)(D, F) * (D ** -0.5)),
            "w_down": _w((lambda *s: torch.randn(*s, dtype=torch.bfloat16) * 0.8)(F, D) * (F ** -0.5)),
        }
    _B_in = _B_setup()

    return {
        "A_x": _A_in["x"],
        "A_wqkv": _A_in["wqkv"],
        "A_wo": _A_in["wo"],
        "B_x": _B_in["x"],
        "B_w_gate": _B_in["w_gate"],
        "B_w_up": _B_in["w_up"],
        "B_w_down": _B_in["w_down"],
    }

def reference(A_x, A_wqkv, A_wo, B_x, B_w_gate, B_w_up, B_w_down):
    def _A_ref(x, wqkv, wo):
        B, S, D = x.shape
        H = 32; Dh = D // H
        qkv = (lambda x, *d: x.permute(*d))((x @ wqkv).reshape(B, S, 3, H, Dh), 2, 0, 3, 1, 4)
        q, k, v = qkv[0], qkv[1], qkv[2]
        phi = lambda t: torch.where(t > 0, t + 1, torch.exp(t)) + 1e-6
        pq, pk = phi(q), phi(k)
        kv = torch.einsum("bhsd,bhse->bhde", pk, v)
        z = torch.einsum("bhsd->bhd", pk)
        num = torch.einsum("bhqd,bhde->bhqe", pq, kv)
        den = torch.einsum("bhqd,bhd->bhq", pq, z)[..., None] + 1e-6
        o = num / den
        return (lambda x, *d: x.permute(*d))(o, 0, 2, 1, 3).reshape(B, S, D) @ wo

    def _B_ref(x, w_gate, w_up, w_down):
        g = torch.einsum("bsd,df->bsf", x, w_gate)
        u = torch.einsum("bsd,df->bsf", x, w_up)
        h = g * u
        return torch.einsum("bsf,fd->bsd", h, w_down)

    x = A_x
    x = x + _A_ref(_layernorm(x, axis=-1), A_wqkv, A_wo)
    x = x + _B_ref(_layernorm(x, axis=-1), B_w_gate, B_w_up, B_w_down)
    x = x + _A_ref(_layernorm(x, axis=-1), A_wqkv, A_wo)
    x = x + _B_ref(_layernorm(x, axis=-1), B_w_gate, B_w_up, B_w_down)
    return x
```

```asm
; @launch grid=(256,1,1) block=(256,1,1) lds=163840
.amdgcn_target "amdgcn-amd-amdhsa--gfx950"
.text
.globl interleave_layers__linear_attn_block__glu_gated_bilinear__prompt_kernel
.p2align 8
.type interleave_layers__linear_attn_block__glu_gated_bilinear__prompt_kernel,@function
interleave_layers__linear_attn_block__glu_gated_bilinear__prompt_kernel:
    s_cmp_ge_u32 s2, 256
    s_cbranch_scc1 L_end
    s_load_dwordx16 s[20:35], s[0:1], 0
    s_load_dwordx4 s[36:39], s[0:1], 64
    s_bfe_u32 s16, s2, 0x20001
    s_lshl_b32 s16, s16, 2
    s_bfe_u32 s3, s2, 0x20003
    s_add_u32 s16, s16, s3
    s_and_b32 s17, s2, 1
    s_lshl_b32 s17, s17, 3
    s_lshr_b32 s3, s2, 5
    s_add_u32 s17, s17, s3
    s_lshr_b32 s19, s17, 1
    s_and_b32 s40, s17, 1
    v_lshrrev_b32 v10, 6, v0
    v_lshlrev_b32 v9, 4, v0
    v_readfirstlane_b32 s18, v10
    v_mov_b32 v11, v0
    v_and_b32 v0, 63, v0
    v_lshlrev_b32 v1, 4, v0
    s_mov_b32 s76, -24
    v_mov_b32 v8, 0
    v_mov_b32 v140, v11
    s_lshl_b32 s72, s16, 3
    s_lshl_b32 s3, s40, 2
    s_add_u32 s71, s72, s3
    s_add_u32 s71, s71, s18
    s_lshl_b32 s3, s18, 1
    s_add_u32 s72, s72, s3
    s_mul_i32 s77, s17, 163840
    s_add_u32 s77, s77, 3244032
    s_waitcnt lgkmcnt(0)
    s_mov_b32 s4, s38
    s_and_b32 s5, s39, 0xffff
    s_mov_b32 s6, 43376640
    s_mov_b32 s7, 0x20000
    s_mov_b32 s12, s38
    s_and_b32 s13, s39, 0xffff
    s_mov_b32 s14, 0
    s_mov_b32 s15, 0x20000
    s_xor_b32 s3, s18, 3
    s_or_b32 s3, s2, s3
    s_cmp_lg_u32 s3, 0
    s_cbranch_scc1 L_noinit_1
    v_mov_b32 v11, 0
    v_lshlrev_b32 v10, 8, v0
    s_mov_b32 exec_hi, 0xffff
    buffer_store_dword v11, v10, s[4:7], 0 offen sc1
    s_mov_b64 exec, -1
L_noinit_1:
    s_mov_b32 s8, s20
    s_and_b32 s9, s21, 0xffff
    s_mov_b32 s10, 2621440
    s_mov_b32 s11, 0x20000
    v_and_b32 v10, 15, v0
    v_mul_u32_u24 v10, 1280, v10
    v_lshrrev_b32 v11, 4, v0
    v_lshl_add_u32 v10, v11, 3, v10
    s_mul_i32 s53, s19, 160
    s_mul_i32 s52, s71, 20480
    s_add_u32 s52, s52, s53
    buffer_load_dwordx2 v[40:41], v10, s[8:11], s52 offen offset:0
    buffer_load_dwordx2 v[42:43], v10, s[8:11], s52 offen offset:32
    buffer_load_dwordx2 v[44:45], v10, s[8:11], s52 offen offset:64
    buffer_load_dwordx2 v[46:47], v10, s[8:11], s52 offen offset:96
    buffer_load_dwordx2 v[48:49], v10, s[8:11], s52 offen offset:128
    s_lshl_b32 s92, s18, 14
    s_add_u32 s92, s92, 90112
    s_max_u32 s92, s92, 98304
    s_mov_b32 s91, 0
    s_mov_b32 s82, 0
    s_lshl_b32 s79, s18, 4
    s_add_u32 s79, s79, s16
    s_cmp_lt_u32 s79, 20
    s_cselect_b32 s90, 1, 0
    s_cbranch_scc0 L_noqkv_2
    v_and_b32 v12, 15, v0
    v_lshrrev_b32 v13, 4, v0
    s_mov_b32 s8, s22
    s_and_b32 s9, s23, 0xffff
    s_mov_b32 s10, 2457600
    s_mov_b32 s11, 0x20000
    s_mov_b32 s83, 3840
    s_mov_b32 s54, 8
    s_mul_i32 s55, s17, 20
    s_add_u32 s55, s55, s79
    s_mul_i32 s52, s79, 5120
    s_add_u32 s52, s52, s77
    s_lshl_b32 s91, s79, 11
    s_sub_u32 s91, 97280, s91
    s_lshl_b32 s55, s55, 9
    s_add_u32 s55, s55, 131072
    v_mul_u32_u24 v15, 205, v12
    v_lshrrev_b32 v15, 10, v15
    v_mul_u32_u24 v16, 5, v15
    v_sub_u32 v14, v12, v16
    v_lshlrev_b32 v14, 4, v14
    v_add_u32 v16, 1, v15
    v_cmp_eq_u32 vcc, 2, v15
    s_nop 1
    v_cndmask_b32 v16, v16, 0, vcc
    s_movk_i32 s3, 1280
    v_mad_u32_u24 v14, v16, s3, v14
    s_mul_i32 s3, s17, 80
    v_add_u32 v14, s3, v14
    v_bfrev_b32 v16, 1
    v_cmp_eq_u32 vcc, 15, v12
    s_nop 1
    v_cndmask_b32 v14, v14, v16, vcc
    s_lshr_b32 s84, s79, 1
    s_mul_i32 s84, s84, 80
    s_and_b32 s3, s79, 1
    s_lshl_b32 s3, s3, 5
    s_add_u32 s84, s84, s3
    s_mov_b32 s85, 8
    s_mov_b32 s86, 4
    s_mov_b32 s87, 16
    s_cmp_lt_u32 s79, 16
    s_cbranch_scc1 L_issueq_3
    s_sub_u32 s84, s79, 16
    s_mul_i32 s84, s84, 160
    s_add_u32 s84, s84, 64
    s_mov_b32 s85, 80
    s_mov_b32 s86, 8
    s_mov_b32 s87, 4
    s_branch L_issueq_3
L_issueq_3:
    v_mad_u32_u24 v14, v13, s83, v14
    s_mul_i32 s84, s84, s83
    s_mul_i32 s85, s85, s83
    s_mul_i32 s86, s86, s83
    s_mul_i32 s87, s87, s83
    s_lshl_b32 s3, s82, 13
    s_add_u32 s56, s92, s3
    s_mov_b32 s3, s84
    s_add_u32 m0, s56, 0
    s_nop 0
    buffer_load_dwordx4 v14, s[8:11], s3 offen lds
    s_mov_b32 s3, s84
    s_add_u32 s3, s3, s86
    s_add_u32 m0, s56, 1024
    s_nop 0
    buffer_load_dwordx4 v14, s[8:11], s3 offen lds
    s_mov_b32 s3, s84
    s_add_u32 s3, s3, s85
    s_add_u32 m0, s56, 2048
    s_nop 0
    buffer_load_dwordx4 v14, s[8:11], s3 offen lds
    s_mov_b32 s3, s84
    s_add_u32 s3, s3, s85
    s_add_u32 s3, s3, s86
    s_add_u32 m0, s56, 3072
    s_nop 0
    buffer_load_dwordx4 v14, s[8:11], s3 offen lds
    s_mov_b32 s3, s84
    s_add_u32 s3, s3, s87
    s_add_u32 m0, s56, 4096
    s_nop 0
    buffer_load_dwordx4 v14, s[8:11], s3 offen lds
    s_mov_b32 s3, s84
    s_add_u32 s3, s3, s86
    s_add_u32 s3, s3, s87
    s_add_u32 m0, s56, 5120
    s_nop 0
    buffer_load_dwordx4 v14, s[8:11], s3 offen lds
    s_mov_b32 s3, s84
    s_add_u32 s3, s3, s85
    s_add_u32 s3, s3, s87
    s_add_u32 m0, s56, 6144
    s_nop 0
    buffer_load_dwordx4 v14, s[8:11], s3 offen lds
    s_mov_b32 s3, s84
    s_add_u32 s3, s3, s85
    s_add_u32 s3, s3, s86
    s_add_u32 s3, s3, s87
    s_add_u32 m0, s56, 7168
    s_nop 0
    buffer_load_dwordx4 v14, s[8:11], s3 offen lds
    s_mov_b32 s78, s52
    s_mov_b32 s79, s54
    s_mov_b32 s80, s55
    s_mov_b32 s82, 0
L_noqkv_2:
    s_lshl_b32 s42, s18, 11
    v_add_u32 v2, s42, v1
    v_add_u32 v3, 0x10000, v1
    v_add_u32 v4, 0x20000, v1
    s_mov_b32 s41, 0
    s_mov_b32 s44, 0
    s_mov_b32 s45, 16
    s_mov_b32 s46, 32
    s_mov_b32 s48, 16
    s_mul_i32 s3, s19, 86
    s_lshr_b32 s3, s3, 8
    s_mul_i32 s3, s3, 3
    s_sub_u32 s49, s19, s3
    s_mov_b32 s64, 0x358637bd
    s_mov_b32 s65, 0x358637bd
    s_mov_b32 s66, 0x00ff00ff
    s_mov_b32 s67, 0x00ff00ff
    s_mov_b64 s[68:69], 0xffff
    s_mul_i32 s63, s19, 102400
    s_mul_i32 s3, s18, 25600
    s_add_u32 s63, s63, s3
    s_add_u32 s63, s63, 5865472
    s_mul_i32 s3, s18, 14
    s_cmp_eq_u32 s18, 3
    s_cselect_b32 s3, 41, s3
    s_lshl_b32 s73, s3, 10
    s_mul_i32 s3, s3, 5120
    s_mul_i32 s70, s19, 276480
    s_add_u32 s70, s70, s3
    s_add_u32 s70, s70, 11272192
    s_cmp_ge_u32 s18, 2
    s_cselect_b32 s94, 0, 1024
    s_cmp_eq_u32 s17, 15
    s_cselect_b32 s101, 0x40000000, 0
    s_mul_i32 s95, s17, 286720
    s_add_u32 s95, s95, 6684672
    s_lshl_b32 s3, s16, 8
    v_mov_b32 v5, s3
    v_and_b32 v12, 3, v0
    s_lshl_b32 s3, s17, 8
    s_add_u32 s3, s3, 4096
    v_mov_b32 v13, s3
    v_cmp_eq_u32 vcc, 1, v12
    s_nop 1
    v_cndmask_b32 v5, v5, v13, vcc
    s_add_u32 s3, s3, 4096
    v_mov_b32 v13, s3
    v_cmp_eq_u32 vcc, 2, v12
    s_nop 1
    v_cndmask_b32 v5, v5, v13, vcc
    s_xor_b32 s3, s3, 256
    v_mov_b32 v13, s3
    v_cmp_eq_u32 vcc, 3, v12
    s_nop 1
    v_cndmask_b32 v5, v5, v13, vcc
    v_cmp_le_u32 vcc, 100, v140
    s_nop 1
    v_cndmask_b32 v12, 0, 1, vcc
    v_mul_u32_u24 v18, 100, v12
    v_sub_u32 v13, v140, v18
    v_mul_u32_u24 v14, 205, v13
    v_lshrrev_b32 v14, 10, v14
    v_mul_u32_u24 v18, 5, v14
    v_sub_u32 v15, v13, v18
    v_mad_u32_u24 v14, v12, 20, v14
    v_mad_u32_u24 v15, v12, 5, v15
    v_add_u32 v16, 8, v14
    v_mov_b32 v17, v14
    v_subrev_u32 v18, 200, v140
    v_cmp_le_u32 vcc, 205, v140
    s_nop 1
    v_cndmask_b32 v19, 48, 49, vcc
    v_cmp_le_u32 vcc, 200, v140
    s_nop 1
    v_cndmask_b32 v15, v15, v18, vcc
    v_cndmask_b32 v16, v16, 0, vcc
    v_cndmask_b32 v17, v17, v19, vcc
    v_cmp_le_u32 vcc, 210, v140
    s_nop 1
    v_cndmask_b32 v15, v15, 0, vcc
    v_cndmask_b32 v17, v17, 64, vcc
    v_lshrrev_b32 v18, 2, v15
    v_lshrrev_b32 v19, 4, v16
    v_mad_u32_u24 v18, v18, 3, v19
    v_lshlrev_b32 v6, 10, v18
    v_and_b32 v18, 3, v15
    v_lshlrev_b32 v18, 8, v18
    v_and_b32 v19, 15, v16
    v_lshl_add_u32 v19, v19, 4, v18
    v_add_u32 v6, v6, v19
    v_add_u32 v6, 16384, v6
    v_lshrrev_b32 v19, 4, v17
    v_lshlrev_b32 v7, 11, v19
    v_lshrrev_b32 v19, 3, v15
    v_lshl_add_u32 v7, v19, 10, v7
    v_add_u32 v7, v7, v18
    v_and_b32 v19, 15, v17
    v_lshl_add_u32 v7, v19, 4, v7
    v_bfe_u32 v19, v15, 2, 1
    v_lshl_add_u32 v7, v19, 3, v7
    v_add_u32 v7, 53248, v7
    v_lshrrev_b32 v11, 2, v0
    v_lshlrev_b32 v138, 8, v11
    v_and_b32 v11, 3, v0
    v_lshl_add_u32 v138, v11, 3, v138
    v_add_u32 v138, s92, v138
    v_mov_b32 v11, 0x3f803f80
    v_accvgpr_write_b32 a64, v11
    v_accvgpr_write_b32 a65, v11
    v_accvgpr_write_b32 a66, v11
    v_accvgpr_write_b32 a67, v11
    v_lshlrev_b32 v139, 2, v0
    s_waitcnt vmcnt(0)
    s_xor_b32 s3, s18, 3
    s_or_b32 s3, s2, s3
    s_cmp_lg_u32 s3, 0
    s_cbranch_scc1 L_noinit_5
    v_mov_b32 v11, 0
    s_mov_b32 s8, s36
    s_and_b32 s9, s37, 0xffff
    s_mov_b32 s10, 256
    s_mov_b32 s11, 0x20000
    v_mov_b32 v12, 1
    s_mov_b64 exec, 1
    buffer_store_dword v12, v11, s[8:11], 0 offen sc1
    s_mov_b64 exec, -1
L_noinit_5:
    v_lshlrev_b32 v20, 16, v40
    v_and_b32 v21, 0xffff0000, v40
    v_lshlrev_b32 v22, 16, v41
    v_and_b32 v23, 0xffff0000, v41
    v_lshlrev_b32 v24, 16, v42
    v_and_b32 v25, 0xffff0000, v42
    v_lshlrev_b32 v26, 16, v43
    v_and_b32 v27, 0xffff0000, v43
    v_lshlrev_b32 v28, 16, v44
    v_and_b32 v29, 0xffff0000, v44
    v_lshlrev_b32 v30, 16, v45
    v_and_b32 v31, 0xffff0000, v45
    v_lshlrev_b32 v32, 16, v46
    v_and_b32 v33, 0xffff0000, v46
    v_lshlrev_b32 v34, 16, v47
    v_and_b32 v35, 0xffff0000, v47
    v_lshlrev_b32 v36, 16, v48
    v_and_b32 v37, 0xffff0000, v48
    v_lshlrev_b32 v38, 16, v49
    v_and_b32 v39, 0xffff0000, v49
    v_cvt_pk_bf16_f32 v100, v20, v21
    v_cvt_pk_bf16_f32 v101, v22, v23
    v_cvt_pk_bf16_f32 v102, v24, v25
    v_cvt_pk_bf16_f32 v103, v26, v27
    v_cvt_pk_bf16_f32 v104, v28, v29
    v_cvt_pk_bf16_f32 v105, v30, v31
    v_cvt_pk_bf16_f32 v106, v32, v33
    v_cvt_pk_bf16_f32 v107, v34, v35
    v_cvt_pk_bf16_f32 v108, v36, v37
    v_cvt_pk_bf16_f32 v109, v38, v39
    v_mov_b32 v110, v108
    v_mov_b32 v111, v109
    s_mul_i32 s52, s44, 2621440
    s_mul_i32 s53, s71, 20480
    s_add_u32 s52, s52, s53
    s_add_u32 s52, s52, 13492224
    s_lshl_b32 s53, s19, 11
    s_add_u32 s96, s53, s52
    buffer_store_dwordx4 v[100:103], v1, s[4:7], s96 offen sc1
    buffer_store_dwordx4 v[104:107], v1, s[4:7], s96 offen offset:1024 sc1
    v_lshlrev_b32 v20, 16, v100
    v_and_b32 v21, 0xffff0000, v100
    v_lshlrev_b32 v22, 16, v101
    v_and_b32 v23, 0xffff0000, v101
    v_lshlrev_b32 v24, 16, v102
    v_and_b32 v25, 0xffff0000, v102
    v_lshlrev_b32 v26, 16, v103
    v_and_b32 v27, 0xffff0000, v103
    v_lshlrev_b32 v28, 16, v104
    v_and_b32 v29, 0xffff0000, v104
    v_lshlrev_b32 v30, 16, v105
    v_and_b32 v31, 0xffff0000, v105
    v_lshlrev_b32 v32, 16, v106
    v_and_b32 v33, 0xffff0000, v106
    v_lshlrev_b32 v34, 16, v107
    v_and_b32 v35, 0xffff0000, v107
    v_lshlrev_b32 v36, 16, v108
    v_and_b32 v37, 0xffff0000, v108
    v_lshlrev_b32 v38, 16, v109
    v_and_b32 v39, 0xffff0000, v109
    v_permlane16_swap_b32 v108, v110
    v_permlane16_swap_b32 v109, v111
    s_lshr_b32 s53, s19, 1
    s_lshl_b32 s53, s53, 10
    s_and_b32 s3, s19, 1
    s_lshl_b32 s3, s3, 9
    s_add_u32 s53, s53, s3
    s_add_u32 s53, s53, s52
    s_add_u32 s97, s53, 16384
    v_and_b32 v10, 15, v0
    v_lshrrev_b32 v11, 5, v0
    v_lshl_add_u32 v11, v11, 4, v10
    v_lshlrev_b32 v11, 4, v11
    s_mov_b32 exec_lo, 0xffff
    s_mov_b32 exec_hi, 0xffff
    buffer_store_dwordx4 v[108:111], v11, s[4:7], s97 offen sc1
    s_mov_b64 exec, -1
    v_pk_add_f32 v[12:13], v[20:21], v[22:23]
    v_pk_mul_f32 v[14:15], v[20:21], v[20:21]
    v_pk_fma_f32 v[14:15], v[22:23], v[22:23], v[14:15]
    v_pk_add_f32 v[12:13], v[12:13], v[24:25]
    v_pk_fma_f32 v[14:15], v[24:25], v[24:25], v[14:15]
    v_pk_add_f32 v[12:13], v[12:13], v[26:27]
    v_pk_fma_f32 v[14:15], v[26:27], v[26:27], v[14:15]
    v_pk_add_f32 v[12:13], v[12:13], v[28:29]
    v_pk_fma_f32 v[14:15], v[28:29], v[28:29], v[14:15]
    v_pk_add_f32 v[12:13], v[12:13], v[30:31]
    v_pk_fma_f32 v[14:15], v[30:31], v[30:31], v[14:15]
    v_pk_add_f32 v[12:13], v[12:13], v[32:33]
    v_pk_fma_f32 v[14:15], v[32:33], v[32:33], v[14:15]
    v_pk_add_f32 v[12:13], v[12:13], v[34:35]
    v_pk_fma_f32 v[14:15], v[34:35], v[34:35], v[14:15]
    v_pk_add_f32 v[12:13], v[12:13], v[36:37]
    v_pk_fma_f32 v[14:15], v[36:37], v[36:37], v[14:15]
    v_pk_add_f32 v[12:13], v[12:13], v[38:39]
    v_pk_fma_f32 v[14:15], v[38:39], v[38:39], v[14:15]
    v_add_f32 v12, v12, v13
    v_add_f32 v13, v14, v15
    v_mov_b32 v14, v12
    v_mov_b32 v15, v13
    s_nop 0
    v_permlane16_swap_b32 v12, v14
    v_permlane16_swap_b32 v13, v15
    v_add_f32 v12, v12, v14
    v_add_f32 v13, v13, v15
    v_mov_b32 v14, v12
    v_mov_b32 v15, v13
    s_nop 0
    v_permlane32_swap_b32 v12, v14
    v_permlane32_swap_b32 v13, v15
    v_add_f32 v12, v12, v14
    v_add_f32 v13, v13, v15
    s_mul_i32 s52, s44, 131072
    s_lshl_b32 s53, s71, 10
    s_add_u32 s52, s52, s53
    s_lshl_b32 s53, s19, 7
    s_add_u32 s52, s52, s53
    s_add_u32 s98, s52, 622592
    v_lshlrev_b32 v10, 3, v10
    s_mov_b64 exec, s[68:69]
    buffer_store_dwordx2 v[12:13], v10, s[4:7], s98 offen sc1
    s_mov_b64 exec, -1
    s_add_u32 s44, s44, 1
    s_cmp_lg_u32 s90, 1
    s_cbranch_scc1 L_noncrit_4
    s_mov_b32 s88, 0
L_oloop_6:
    s_cmp_eq_u32 s79, 0
    s_cbranch_scc1 L_oskip_7
    ds_read_b64_tr_b16 a[0:1], v138 offset:0
    ds_read_b64_tr_b16 a[2:3], v138 offset:4096
    ds_read_b64_tr_b16 a[4:5], v138 offset:32
    ds_read_b64_tr_b16 a[6:7], v138 offset:4128
    ds_read_b64_tr_b16 a[8:9], v138 offset:64
    ds_read_b64_tr_b16 a[10:11], v138 offset:4160
    ds_read_b64_tr_b16 a[12:13], v138 offset:96
    ds_read_b64_tr_b16 a[14:15], v138 offset:4192
    ds_read_b64_tr_b16 a[16:17], v138 offset:128
    ds_read_b64_tr_b16 a[18:19], v138 offset:4224
    ds_read_b64_tr_b16 a[20:21], v138 offset:160
    ds_read_b64_tr_b16 a[22:23], v138 offset:4256
    ds_read_b64_tr_b16 a[24:25], v138 offset:192
    ds_read_b64_tr_b16 a[26:27], v138 offset:4288
    ds_read_b64_tr_b16 a[28:29], v138 offset:224
    ds_read_b64_tr_b16 a[30:31], v138 offset:4320
    s_cmp_eq_u32 s79, 7
    s_cselect_b32 s89, 2, 1
    s_lshl_b32 s89, s89, 10
    s_waitcnt lgkmcnt(0)
    v_mfma_f32_16x16x32_bf16 a[32:35], a[64:67], a[0:3], 0
    v_mfma_f32_16x16x32_bf16 a[36:39], a[64:67], a[4:7], 0
    v_mfma_f32_16x16x32_bf16 a[40:43], a[64:67], a[8:11], 0
    v_mfma_f32_16x16x32_bf16 a[44:47], a[64:67], a[12:15], 0
    v_mfma_f32_16x16x32_bf16 a[48:51], a[64:67], a[16:19], 0
    v_mfma_f32_16x16x32_bf16 a[52:55], a[64:67], a[20:23], 0
    v_mfma_f32_16x16x32_bf16 a[56:59], a[64:67], a[24:27], 0
    v_mfma_f32_16x16x32_bf16 a[60:63], a[64:67], a[28:31], 0
    buffer_store_dwordx4 a[0:3], v1, s[4:7], s78 offen sc1
    s_add_u32 s78, s78, s89
    buffer_store_dwordx4 a[4:7], v1, s[4:7], s78 offen sc1
    s_add_u32 s78, s78, s89
    buffer_store_dwordx4 a[8:11], v1, s[4:7], s78 offen sc1
    s_add_u32 s78, s78, s89
    buffer_store_dwordx4 a[12:15], v1, s[4:7], s78 offen sc1
    s_add_u32 s78, s78, s89
    buffer_store_dwordx4 a[16:19], v1, s[4:7], s78 offen sc1
    s_add_u32 s78, s78, s89
    s_cmp_eq_u32 s79, 5
    s_cbranch_scc1 L_stdone_8
    s_add_u32 s78, s78, s91
    buffer_store_dwordx4 a[20:23], v1, s[4:7], s78 offen sc1
    s_add_u32 s78, s78, s89
    buffer_store_dwordx4 a[24:27], v1, s[4:7], s78 offen sc1
    s_add_u32 s78, s78, s89
    s_cmp_eq_u32 s79, 7
    s_cbranch_scc1 L_stdone_8
    buffer_store_dwordx4 a[28:31], v1, s[4:7], s78 offen sc1
    s_add_u32 s78, s78, s89
L_stdone_8:
    s_cmp_eq_u32 s80, -1
    s_cbranch_scc1 L_oskip_7
    s_nop 7
    v_accvgpr_read_b32 v142, a32
    v_accvgpr_read_b32 v144, a36
    s_lshl_b64 vcc, s[68:69], 16
    v_cndmask_b32 v142, v142, v144, vcc
    v_accvgpr_read_b32 v144, a40
    s_lshl_b64 vcc, s[68:69], 32
    v_cndmask_b32 v142, v142, v144, vcc
    v_accvgpr_read_b32 v144, a44
    s_lshl_b64 vcc, s[68:69], 48
    v_cndmask_b32 v142, v142, v144, vcc
    buffer_store_dword v142, v139, s[4:7], s80 offen offset:0 sc1
    v_accvgpr_read_b32 v143, a48
    v_accvgpr_read_b32 v144, a52
    s_lshl_b64 vcc, s[68:69], 16
    v_cndmask_b32 v143, v143, v144, vcc
    v_accvgpr_read_b32 v144, a56
    s_lshl_b64 vcc, s[68:69], 32
    v_cndmask_b32 v143, v143, v144, vcc
    v_accvgpr_read_b32 v144, a60
    s_lshl_b64 vcc, s[68:69], 48
    v_cndmask_b32 v143, v143, v144, vcc
    buffer_store_dword v143, v139, s[4:7], s80 offen offset:256 sc1
L_oskip_7:
    s_mov_b32 s78, s81
    s_mov_b32 s79, s82
    s_mov_b32 s80, s83
    v_add_u32 v138, 8192, v138
    s_add_u32 s88, s88, 1
    s_cmp_lt_u32 s88, 2
    s_nop 7
    s_cbranch_scc1 L_oloop_6
L_noncrit_4:
    s_mov_b32 s8, s36
    s_and_b32 s9, s37, 0xffff
    s_mov_b32 s10, 256
    s_mov_b32 s11, 0x20000
    v_mov_b32 v18, 0
    buffer_load_dword v19, v18, s[8:11], 0 offen sc1
    s_waitcnt vmcnt(0)
    s_barrier
    s_cmp_lg_u32 s18, 0
    s_cbranch_scc1 L_noarr_9
    s_mov_b32 s47, 0
L_ipoll_10:
    v_cmp_ne_u32 vcc, 0, v19
    s_add_u32 s47, s47, 1
    s_cbranch_vccnz L_ipollout_11
    s_cmp_gt_u32 s47, 0x40000
    s_cbranch_scc1 L_ipollout_11
    buffer_load_dword v19, v18, s[8:11], 0 offen sc1
    s_waitcnt vmcnt(0)
    s_branch L_ipoll_10
L_ipollout_11:
    v_mov_b32 v19, 1
    s_mov_b64 exec, 3
    buffer_atomic_add v19, v5, s[4:7], 0 offen sc1
    s_mov_b64 exec, -1
L_noarr_9:
    s_cmp_eq_u32 s90, 1
    s_cbranch_scc1 L_rest_15
    s_mov_b32 s80, 0
    s_mov_b32 s81, 0
    s_cmp_eq_u32 s18, 2
    s_cbranch_scc1 L_w2_12
    s_cmp_eq_u32 s18, 3
    s_cbranch_scc1 L_w3_13
    s_mov_b32 s78, 3
    s_mov_b32 s80, 4
    s_add_u32 s79, s16, 12
    s_mov_b32 s81, s79
    s_cmp_lt_u32 s16, 8
    s_cbranch_scc1 L_jobs_14
    s_mov_b32 s78, 2
    s_mov_b32 s80, 0
    s_lshl_b32 s79, s40, 3
    s_add_u32 s79, s79, s16
    s_sub_u32 s79, s79, 8
    s_branch L_jobs_14
L_w2_12:
    s_mov_b32 s78, 3
    s_mov_b32 s80, 4
    s_mov_b32 s79, s16
    s_mov_b32 s81, s16
    s_branch L_jobs_14
L_w3_13:
    s_mov_b32 s78, 5
    s_lshl_b32 s79, s40, 4
    s_add_u32 s79, s79, s16
    s_mov_b32 s80, 5
    s_add_u32 s81, s79, 32
    s_cmp_lt_u32 s79, 22
    s_cbranch_scc1 L_jobs_14
    s_mov_b32 s80, 2
    s_sub_u32 s81, s79, 6
    s_cmp_lt_u32 s79, 26
    s_cbranch_scc1 L_jobs_14
    s_mov_b32 s80, 0
L_jobs_14:
    v_and_b32 v12, 15, v0
    v_lshrrev_b32 v13, 4, v0
    s_nop 1
L_jloop_16:
    s_mov_b32 s54, 0
    s_mov_b32 s52, 0
    s_mov_b32 s55, -1
    s_cmp_eq_u32 s78, 0
    s_cbranch_scc1 L_jnext_21
    s_cmp_eq_u32 s78, 2
    s_cbranch_scc1 L_t2_17
    s_cmp_eq_u32 s78, 5
    s_cbranch_scc1 L_t5_19
L_t3_18:
    s_cmp_eq_u32 s78, 3
    s_cselect_b32 s8, s28, s30
    s_cselect_b32 s9, s29, s31
    s_and_b32 s9, s9, 0xffff
    s_mov_b32 s10, 2211840
    s_mov_b32 s11, 0x20000
    s_mov_b32 s83, 3456
    s_mov_b32 s54, 7
    s_sub_u32 s3, s78, 3
    s_mul_i32 s52, s17, 20
    s_add_u32 s52, s52, s79
    s_mul_i32 s52, s52, 14
    s_add_u32 s52, s52, s3
    s_lshl_b32 s52, s52, 10
    s_add_u32 s52, s52, 6684672
    s_lshl_b32 s55, s17, 1
    s_add_u32 s55, s55, s3
    s_mul_i32 s55, s55, 20
    s_add_u32 s55, s55, s79
    s_lshl_b32 s55, s55, 9
    s_add_u32 s55, s55, 294912
    s_cmp_eq_u32 s17, 15
    s_cselect_b32 s3, 4, 14
    s_cselect_b32 s56, 8, 0
    v_subrev_u32 v15, s56, v12
    v_cmp_le_u32 vcc, 12, v12
    s_nop 1
    v_cndmask_b32 v15, v12, v15, vcc
    v_lshlrev_b32 v14, 4, v15
    s_mul_i32 s56, s17, 224
    v_add_u32 v14, s56, v14
    v_bfrev_b32 v16, 1
    v_cmp_gt_u32 s[56:57], s3, v12
    v_cmp_le_u32 vcc, 12, v12
    s_nop 0
    s_or_b64 vcc, vcc, s[56:57]
    v_cndmask_b32 v14, v16, v14, vcc
    v_cmp_le_u32 vcc, 14, v12
    s_nop 1
    v_cndmask_b32 v14, v14, v16, vcc
    s_lshr_b32 s84, s79, 1
    s_mul_i32 s84, s84, 80
    s_and_b32 s3, s79, 1
    s_lshl_b32 s3, s3, 5
    s_add_u32 s84, s84, s3
    s_mov_b32 s85, 8
    s_mov_b32 s86, 4
    s_mov_b32 s87, 16
    s_cmp_lt_u32 s79, 16
    s_cbranch_scc1 L_issue_20
    s_sub_u32 s84, s79, 16
    s_mul_i32 s84, s84, 160
    s_add_u32 s84, s84, 64
    s_mov_b32 s85, 80
    s_mov_b32 s86, 8
    s_mov_b32 s87, 4
    s_branch L_issue_20
L_t2_17:
    s_mov_b32 s8, s24
    s_and_b32 s9, s25, 0xffff
    s_mov_b32 s10, 819200
    s_mov_b32 s11, 0x20000
    s_mul_i32 s52, s19, 20
    s_add_u32 s52, s52, s79
    s_mul_i32 s52, s52, 5120
    s_add_u32 s52, s52, 5865472
    s_mul_i32 s84, s79, 40
    s_mov_b32 s85, 8
    s_mov_b32 s86, 4
    s_mov_b32 s87, 16
    s_cmp_lt_u32 s79, 16
    s_cbranch_scc1 L_sh_22
    s_sub_u32 s84, s79, 16
    s_mul_i32 s84, s84, 160
    s_add_u32 s84, s84, 32
    s_mov_b32 s85, 80
    s_mov_b32 s86, 40
    s_mov_b32 s87, 4
    s_branch L_sh_22
L_t5_19:
    s_mov_b32 s8, s32
    s_and_b32 s9, s33, 0xffff
    s_mov_b32 s10, 2211840
    s_mov_b32 s11, 0x20000
    s_mul_i32 s52, s19, 54
    s_add_u32 s52, s52, s79
    s_mul_i32 s52, s52, 5120
    s_add_u32 s52, s52, 11272192
    s_mul_i32 s3, s79, 171
    s_lshr_b32 s3, s3, 9
    s_mul_i32 s84, s3, 16
    s_lshl_b32 s3, s79, 5
    s_add_u32 s84, s84, s3
    s_mov_b32 s85, 8
    s_mov_b32 s86, 4
    s_mov_b32 s87, 16
    s_cmp_lt_u32 s79, 46
    s_cbranch_scc1 L_sh_22
    s_sub_u32 s84, s79, 46
    s_mul_i32 s84, s84, 224
    s_add_u32 s84, s84, 96
    s_cmp_eq_u32 s79, 53
    s_cselect_b32 s85, 48, 112
    s_mov_b32 s86, 8
    s_mov_b32 s87, 4
L_sh_22:
    s_mov_b32 s83, 1280
    s_mov_b32 s54, 5
    s_mul_i32 s3, s19, 160
    v_lshlrev_b32 v14, 4, v12
    v_add_u32 v14, s3, v14
    v_bfrev_b32 v16, 1
    v_cmp_le_u32 vcc, 10, v12
    s_nop 1
    v_cndmask_b32 v14, v14, v16, vcc
    s_nop 1
L_issue_20:
    v_mad_u32_u24 v14, v13, s83, v14
    s_mul_i32 s84, s84, s83
    s_mul_i32 s85, s85, s83
    s_mul_i32 s86, s86, s83
    s_mul_i32 s87, s87, s83
    s_lshl_b32 s3, s82, 13
    s_add_u32 s56, s92, s3
    s_mov_b32 s3, s84
    s_add_u32 m0, s56, 0
    s_nop 0
    buffer_load_dwordx4 v14, s[8:11], s3 offen lds
    s_mov_b32 s3, s84
    s_add_u32 s3, s3, s86
    s_add_u32 m0, s56, 1024
    s_nop 0
    buffer_load_dwordx4 v14, s[8:11], s3 offen lds
    s_mov_b32 s3, s84
    s_add_u32 s3, s3, s85
    s_add_u32 m0, s56, 2048
    s_nop 0
    buffer_load_dwordx4 v14, s[8:11], s3 offen lds
    s_mov_b32 s3, s84
    s_add_u32 s3, s3, s85
    s_add_u32 s3, s3, s86
    s_add_u32 m0, s56, 3072
    s_nop 0
    buffer_load_dwordx4 v14, s[8:11], s3 offen lds
    s_mov_b32 s3, s84
    s_add_u32 s3, s3, s87
    s_add_u32 m0, s56, 4096
    s_nop 0
    buffer_load_dwordx4 v14, s[8:11], s3 offen lds
    s_mov_b32 s3, s84
    s_add_u32 s3, s3, s86
    s_add_u32 s3, s3, s87
    s_add_u32 m0, s56, 5120
    s_nop 0
    buffer_load_dwordx4 v14, s[8:11], s3 offen lds
    s_mov_b32 s3, s84
    s_add_u32 s3, s3, s85
    s_add_u32 s3, s3, s87
    s_add_u32 m0, s56, 6144
    s_nop 0
    buffer_load_dwordx4 v14, s[8:11], s3 offen lds
    s_mov_b32 s3, s84
    s_add_u32 s3, s3, s85
    s_add_u32 s3, s3, s86
    s_add_u32 s3, s3, s87
    s_add_u32 m0, s56, 7168
    s_nop 0
    buffer_load_dwordx4 v14, s[8:11], s3 offen lds
L_jnext_21:
    s_mov_b32 s58, s61
    s_mov_b32 s59, s96
    s_mov_b32 s60, s97
    s_mov_b32 s61, s52
    s_mov_b32 s96, s54
    s_mov_b32 s97, s55
    s_mov_b32 s78, s80
    s_mov_b32 s79, s81
    s_add_u32 s82, s82, 1
    s_cmp_lt_u32 s82, 2
    s_cbranch_scc1 L_jloop_16
    s_mov_b32 s78, s58
    s_mov_b32 s79, s59
    s_mov_b32 s80, s60
    s_mov_b32 s81, s61
    s_mov_b32 s82, s96
    s_mov_b32 s83, s97
L_rest_15:
    s_sub_u32 s58, s44, 1
    s_mul_i32 s58, s58, 2621440
    s_mul_i32 s3, s72, 20480
    s_add_u32 s58, s58, s3
    s_add_u32 s58, s58, 13492224
    s_add_u32 s59, s58, 20480
    s_sub_u32 s52, s44, 1
    s_mul_i32 s52, s52, 131072
    s_lshl_b32 s53, s72, 10
    s_add_u32 s52, s52, s53
    s_add_u32 s52, s52, 622592
    v_and_b32 v112, 15, v0
    v_lshlrev_b32 v112, 3, v112
    v_and_b32 v113, 48, v0
    v_lshl_add_u32 v112, v113, 4, v112
    s_cmp_lg_u32 s18, 0
    s_cbranch_scc1 L_nopoll_23
    s_mov_b64 exec, 3
    s_mov_b32 s47, 0
L_poll_24:
    buffer_load_dword v19, v5, s[4:7], 0 offen sc1
    s_add_u32 s47, s47, 1
    s_cmp_gt_u32 s47, 0x40000
    s_cbranch_scc1 L_pollout_25
    s_waitcnt vmcnt(0)
    v_cmp_gt_u32 vcc, s45, v19
    s_nop 0
    s_cbranch_vccnz L_poll_24
L_pollout_25:
    s_mov_b64 exec, -1
L_nopoll_23:
    s_barrier
    s_add_u32 m0, s42, 0
    s_add_u32 s43, s77, 0
    buffer_load_dwordx4 v2, s[4:7], s43 offen sc1 lds
    buffer_load_dwordx4 v2, s[4:7], s43 offen offset:1024 sc1 lds
    s_add_u32 m0, s42, 8192
    s_add_u32 s43, s77, 8192
    buffer_load_dwordx4 v2, s[4:7], s43 offen sc1 lds
    buffer_load_dwordx4 v2, s[4:7], s43 offen offset:1024 sc1 lds
    s_add_u32 m0, s42, 16384
    s_add_u32 s43, s77, 16384
    buffer_load_dwordx4 v2, s[4:7], s43 offen sc1 lds
    buffer_load_dwordx4 v2, s[4:7], s43 offen offset:1024 sc1 lds
    s_add_u32 m0, s42, 24576
    s_add_u32 s43, s77, 24576
    buffer_load_dwordx4 v2, s[4:7], s43 offen sc1 lds
    buffer_load_dwordx4 v2, s[4:7], s43 offen offset:1024 sc1 lds
    s_branch L_k1
L_k1:
    buffer_load_dwordx4 a[100:103], v1, s[4:7], s58 offen offset:0 sc1
    buffer_load_dwordx4 a[104:107], v1, s[4:7], s59 offen offset:0 sc1
    buffer_load_dwordx4 a[108:111], v1, s[4:7], s58 offen offset:1024 sc1
    buffer_load_dwordx4 a[112:115], v1, s[4:7], s59 offen offset:1024 sc1
    buffer_load_dwordx2 v[104:105], v112, s[4:7], s52 offen offset:0 sc1
    buffer_load_dwordx2 v[106:107], v112, s[4:7], s52 offen offset:128 sc1
    buffer_load_dwordx2 v[108:109], v112, s[4:7], s52 offen offset:1024 sc1
    buffer_load_dwordx2 v[110:111], v112, s[4:7], s52 offen offset:1152 sc1
    s_cmp_lg_u32 s41, 0
    s_cbranch_scc1 L_l0_26
    s_mul_i32 s100, s17, 10240
    s_add_u32 s100, s100, 131072
    v_lshrrev_b32 v136, 2, v9
    v_and_b32 v136, 511, v136
    buffer_load_dword v116, v136, s[4:7], s100 offen offset:0 sc1
    buffer_load_dword v117, v136, s[4:7], s100 offen offset:512 sc1
    buffer_load_dword v118, v136, s[4:7], s100 offen offset:1024 sc1
    buffer_load_dword v119, v136, s[4:7], s100 offen offset:1536 sc1
    buffer_load_dword v120, v136, s[4:7], s100 offen offset:2048 sc1
    buffer_load_dword v121, v136, s[4:7], s100 offen offset:2560 sc1
    buffer_load_dword v122, v136, s[4:7], s100 offen offset:3072 sc1
    buffer_load_dword v123, v136, s[4:7], s100 offen offset:3584 sc1
    s_add_u32 s100, s100, 4096
    buffer_load_dword v124, v136, s[4:7], s100 offen offset:0 sc1
    buffer_load_dword v125, v136, s[4:7], s100 offen offset:512 sc1
    buffer_load_dword v126, v136, s[4:7], s100 offen offset:1024 sc1
    buffer_load_dword v127, v136, s[4:7], s100 offen offset:1536 sc1
    buffer_load_dword v128, v136, s[4:7], s100 offen offset:2048 sc1
    buffer_load_dword v129, v136, s[4:7], s100 offen offset:2560 sc1
    buffer_load_dword v130, v136, s[4:7], s100 offen offset:3072 sc1
    buffer_load_dword v131, v136, s[4:7], s100 offen offset:3584 sc1
    s_add_u32 s100, s100, 4096
    buffer_load_dword v132, v136, s[4:7], s100 offen offset:0 sc1
    buffer_load_dword v133, v136, s[4:7], s100 offen offset:512 sc1
    buffer_load_dword v134, v136, s[4:7], s100 offen offset:1024 sc1
    buffer_load_dword v135, v136, s[4:7], s100 offen offset:1536 sc1
L_l0_26:
    buffer_load_dwordx4 a[116:119], v1, s[4:7], s58 offen offset:2048 sc1
    buffer_load_dwordx4 a[120:123], v1, s[4:7], s59 offen offset:2048 sc1
    s_waitcnt vmcnt(32)
    s_barrier
    ds_read_b128 v[80:83], v1 offset:0
    ds_read_b128 v[84:87], v1 offset:1024
    ds_read_b128 v[88:91], v1 offset:2048
    ds_read_b128 v[92:95], v1 offset:3072
    ds_read_b128 v[96:99], v1 offset:4096
    s_waitcnt vmcnt(8) lgkmcnt(4)
    v_mfma_f32_16x16x32_bf16 v[40:43], a[100:103], v[80:83], 0
    ds_read_b128 v[100:103], v1 offset:5120
    s_waitcnt lgkmcnt(4)
    v_mfma_f32_16x16x32_bf16 v[44:47], a[104:107], v[80:83], 0
    buffer_load_dwordx4 a[124:127], v1, s[4:7], s58 offen offset:3072 sc1
    v_mfma_f32_16x16x32_bf16 v[48:51], a[100:103], v[84:87], 0
    ds_read_b128 v[80:83], v1 offset:6144
    s_waitcnt lgkmcnt(4)
    v_mfma_f32_16x16x32_bf16 v[52:55], a[104:107], v[84:87], 0
    buffer_load_dwordx4 a[128:131], v1, s[4:7], s59 offen offset:3072 sc1
    v_mfma_f32_16x16x32_bf16 v[56:59], a[100:103], v[88:91], 0
    ds_read_b128 v[84:87], v1 offset:7168
    s_waitcnt lgkmcnt(4)
    v_mfma_f32_16x16x32_bf16 v[60:63], a[104:107], v[88:91], 0
    v_mfma_f32_16x16x32_bf16 v[64:67], a[100:103], v[92:95], 0
    ds_read_b128 v[88:91], v1 offset:8192
    s_waitcnt lgkmcnt(4)
    v_mfma_f32_16x16x32_bf16 v[68:71], a[104:107], v[92:95], 0
    s_cmp_lg_u32 s41, 0
    s_cbranch_scc1 L_l0_27
    s_add_u32 m0, s42, 32768
    s_add_u32 s43, s77, 32768
    buffer_load_dwordx4 v2, s[4:7], s43 offen sc1 lds
    buffer_load_dwordx4 v2, s[4:7], s43 offen offset:1024 sc1 lds
L_l0_27:
    v_mfma_f32_16x16x32_bf16 v[72:75], a[100:103], v[96:99], 0
    ds_read_b128 v[92:95], v1 offset:9216
    s_waitcnt vmcnt(8) lgkmcnt(4)
    v_mfma_f32_16x16x32_bf16 v[76:79], a[104:107], v[96:99], 0
    s_add_u32 s58, s58, 4096
    s_add_u32 s59, s59, 4096
    v_mfma_f32_16x16x32_bf16 v[40:43], a[108:111], v[100:103], v[40:43]
    ds_read_b128 v[96:99], v1 offset:10240
    s_waitcnt lgkmcnt(4)
    v_mfma_f32_16x16x32_bf16 v[44:47], a[112:115], v[100:103], v[44:47]
    buffer_load_dwordx4 a[132:135], v1, s[4:7], s58 offen offset:0 sc1
    v_mfma_f32_16x16x32_bf16 v[48:51], a[108:111], v[80:83], v[48:51]
    ds_read_b128 v[100:103], v1 offset:11264
    s_waitcnt lgkmcnt(4)
    v_mfma_f32_16x16x32_bf16 v[52:55], a[112:115], v[80:83], v[52:55]
    buffer_load_dwordx4 a[136:139], v1, s[4:7], s59 offen offset:0 sc1
    v_mfma_f32_16x16x32_bf16 v[56:59], a[108:111], v[84:87], v[56:59]
    ds_read_b128 v[80:83], v1 offset:12288
    s_waitcnt lgkmcnt(4)
    v_mfma_f32_16x16x32_bf16 v[60:63], a[112:115], v[84:87], v[60:63]
    s_cmp_lg_u32 s41, 0
    s_cbranch_scc1 L_l0_28
    s_add_u32 m0, s42, 40960
    s_add_u32 s43, s77, 40960
    buffer_load_dwordx4 v2, s[4:7], s43 offen sc1 lds
    buffer_load_dwordx4 v2, s[4:7], s43 offen offset:1024 sc1 lds
L_l0_28:
    v_mfma_f32_16x16x32_bf16 v[64:67], a[108:111], v[88:91], v[64:67]
    ds_read_b128 v[84:87], v1 offset:13312
    s_waitcnt lgkmcnt(4)
    v_mfma_f32_16x16x32_bf16 v[68:71], a[112:115], v[88:91], v[68:71]
    buffer_load_dwordx4 a[140:143], v1, s[4:7], s58 offen offset:1024 sc1
    v_mfma_f32_16x16x32_bf16 v[72:75], a[108:111], v[92:95], v[72:75]
    ds_read_b128 v[88:91], v1 offset:14336
    s_waitcnt vmcnt(5) lgkmcnt(4)
    v_mfma_f32_16x16x32_bf16 v[76:79], a[112:115], v[92:95], v[76:79]
    buffer_load_dwordx4 a[144:147], v1, s[4:7], s59 offen offset:1024 sc1
    v_mfma_f32_16x16x32_bf16 v[40:43], a[116:119], v[96:99], v[40:43]
    ds_read_b128 v[92:95], v1 offset:15360
    s_waitcnt lgkmcnt(4)
    v_mfma_f32_16x16x32_bf16 v[44:47], a[120:123], v[96:99], v[44:47]
    s_cmp_lg_u32 s41, 0
    s_cbranch_scc1 L_l0_29
    s_add_u32 m0, s42, 49152
    s_add_u32 s43, s77, 49152
    buffer_load_dwordx4 v2, s[4:7], s43 offen sc1 lds
    buffer_load_dwordx4 v2, s[4:7], s43 offen offset:1024 sc1 lds
L_l0_29:
    v_mfma_f32_16x16x32_bf16 v[48:51], a[116:119], v[100:103], v[48:51]
    ds_read_b128 v[96:99], v1 offset:16384
    s_waitcnt lgkmcnt(4)
    v_mfma_f32_16x16x32_bf16 v[52:55], a[120:123], v[100:103], v[52:55]
    buffer_load_dwordx4 a[148:151], v1, s[4:7], s58 offen offset:2048 sc1
    v_mfma_f32_16x16x32_bf16 v[56:59], a[116:119], v[80:83], v[56:59]
    ds_read_b128 v[100:103], v1 offset:17408
    s_waitcnt lgkmcnt(4)
    v_mfma_f32_16x16x32_bf16 v[60:63], a[120:123], v[80:83], v[60:63]
    buffer_load_dwordx4 a[152:155], v1, s[4:7], s59 offen offset:2048 sc1
    v_mfma_f32_16x16x32_bf16 v[64:67], a[116:119], v[84:87], v[64:67]
    ds_read_b128 v[80:83], v1 offset:18432
    s_waitcnt lgkmcnt(4)
    v_mfma_f32_16x16x32_bf16 v[68:71], a[120:123], v[84:87], v[68:71]
    s_cmp_lg_u32 s41, 0
    s_cbranch_scc1 L_l0_30
    s_add_u32 m0, s42, 57344
    s_add_u32 s43, s77, 57344
    buffer_load_dwordx4 v2, s[4:7], s43 offen sc1 lds
    buffer_load_dwordx4 v2, s[4:7], s43 offen offset:1024 sc1 lds
L_l0_30:
    v_mfma_f32_16x16x32_bf16 v[72:75], a[116:119], v[88:91], v[72:75]
    ds_read_b128 v[84:87], v1 offset:19456
    s_waitcnt vmcnt(6) lgkmcnt(4)
    v_mfma_f32_16x16x32_bf16 v[76:79], a[120:123], v[88:91], v[76:79]
    buffer_load_dwordx4 a[156:159], v1, s[4:7], s58 offen offset:3072 sc1
    v_mfma_f32_16x16x32_bf16 v[40:43], a[124:127], v[92:95], v[40:43]
    ds_read_b128 v[88:91], v1 offset:20480
    s_waitcnt lgkmcnt(4)
    v_mfma_f32_16x16x32_bf16 v[44:47], a[128:131], v[92:95], v[44:47]
    s_waitcnt vmcnt(13)
    s_barrier
    v_mfma_f32_16x16x32_bf16 v[48:51], a[124:127], v[96:99], v[48:51]
    ds_read_b128 v[92:95], v1 offset:21504
    s_waitcnt lgkmcnt(4)
    v_mfma_f32_16x16x32_bf16 v[52:55], a[128:131], v[96:99], v[52:55]
    buffer_load_dwordx4 a[160:163], v1, s[4:7], s59 offen offset:3072 sc1
    v_mfma_f32_16x16x32_bf16 v[56:59], a[124:127], v[100:103], v[56:59]
    ds_read_b128 v[96:99], v1 offset:22528
    s_waitcnt lgkmcnt(4)
    v_mfma_f32_16x16x32_bf16 v[60:63], a[128:131], v[100:103], v[60:63]
    s_cmp_lg_u32 s41, 0
    s_cbranch_scc1 L_l0_31
    s_add_u32 m0, s42, 65536
    s_add_u32 s43, s77, 65536
    buffer_load_dwordx4 v2, s[4:7], s43 offen sc1 lds
    buffer_load_dwordx4 v2, s[4:7], s43 offen offset:1024 sc1 lds
L_l0_31:
    v_mfma_f32_16x16x32_bf16 v[64:67], a[124:127], v[80:83], v[64:67]
    ds_read_b128 v[100:103], v1 offset:23552
    s_waitcnt lgkmcnt(4)
    v_mfma_f32_16x16x32_bf16 v[68:71], a[128:131], v[80:83], v[68:71]
    s_add_u32 s58, s58, 4096
    s_add_u32 s59, s59, 4096
    v_mfma_f32_16x16x32_bf16 v[72:75], a[124:127], v[84:87], v[72:75]
    ds_read_b128 v[80:83], v1 offset:24576
    s_waitcnt vmcnt(6) lgkmcnt(4)
    v_mfma_f32_16x16x32_bf16 v[76:79], a[128:131], v[84:87], v[76:79]
    buffer_load_dwordx4 a[164:167], v1, s[4:7], s58 offen offset:0 sc1
    v_mfma_f32_16x16x32_bf16 v[40:43], a[132:135], v[88:91], v[40:43]
    ds_read_b128 v[84:87], v1 offset:25600
    s_waitcnt lgkmcnt(4)
    v_mfma_f32_16x16x32_bf16 v[44:47], a[136:139], v[88:91], v[44:47]
    buffer_load_dwordx4 a[168:171], v1, s[4:7], s59 offen offset:0 sc1
    v_mfma_f32_16x16x32_bf16 v[48:51], a[132:135], v[92:95], v[48:51]
    ds_read_b128 v[88:91], v1 offset:26624
    s_waitcnt lgkmcnt(4)
    v_mfma_f32_16x16x32_bf16 v[52:55], a[136:139], v[92:95], v[52:55]
    s_cmp_lg_u32 s41, 0
    s_cbranch_scc1 L_l0_32
    s_add_u32 m0, s42, 73728
    s_add_u32 s43, s77, 73728
    buffer_load_dwordx4 v2, s[4:7], s43 offen sc1 lds
    buffer_load_dwordx4 v2, s[4:7], s43 offen offset:1024 sc1 lds
L_l0_32:
    v_mfma_f32_16x16x32_bf16 v[56:59], a[132:135], v[96:99], v[56:59]
    ds_read_b128 v[92:95], v1 offset:27648
    s_waitcnt lgkmcnt(4)
    v_mfma_f32_16x16x32_bf16 v[60:63], a[136:139], v[96:99], v[60:63]
    buffer_load_dwordx4 a[172:175], v1, s[4:7], s58 offen offset:1024 sc1
    v_mfma_f32_16x16x32_bf16 v[64:67], a[132:135], v[100:103], v[64:67]
    ds_read_b128 v[96:99], v1 offset:28672
    s_waitcnt lgkmcnt(4)
    v_mfma_f32_16x16x32_bf16 v[68:71], a[136:139], v[100:103], v[68:71]
    buffer_load_dwordx4 v[172:175], v1, s[4:7], s59 offen offset:1024 sc1
    v_mfma_f32_16x16x32_bf16 v[72:75], a[132:135], v[80:83], v[72:75]
    ds_read_b128 v[100:103], v1 offset:29696
    s_waitcnt vmcnt(8) lgkmcnt(4)
    v_mfma_f32_16x16x32_bf16 v[76:79], a[136:139], v[80:83], v[76:79]
    s_cmp_lg_u32 s41, 0
    s_cbranch_scc1 L_l0_33
    s_add_u32 m0, s42, 81920
    s_add_u32 s43, s77, 81920
    buffer_load_dwordx4 v2, s[4:7], s43 offen sc1 lds
    buffer_load_dwordx4 v2, s[4:7], s43 offen offset:1024 sc1 lds
L_l0_33:
    v_mfma_f32_16x16x32_bf16 v[40:43], a[140:143], v[84:87], v[40:43]
    ds_read_b128 v[80:83], v1 offset:30720
    s_waitcnt lgkmcnt(4)
    v_mfma_f32_16x16x32_bf16 v[44:47], a[144:147], v[84:87], v[44:47]
    buffer_load_dwordx4 v[176:179], v1, s[4:7], s58 offen offset:2048 sc1
    v_mfma_f32_16x16x32_bf16 v[48:51], a[140:143], v[88:91], v[48:51]
    ds_read_b128 v[84:87], v1 offset:31744
    s_waitcnt lgkmcnt(4)
    v_mfma_f32_16x16x32_bf16 v[52:55], a[144:147], v[88:91], v[52:55]
    buffer_load_dwordx4 v[180:183], v1, s[4:7], s59 offen offset:2048 sc1
    v_mfma_f32_16x16x32_bf16 v[56:59], a[140:143], v[92:95], v[56:59]
    ds_read_b128 v[88:91], v1 offset:32768
    s_waitcnt lgkmcnt(4)
    v_mfma_f32_16x16x32_bf16 v[60:63], a[144:147], v[92:95], v[60:63]
    s_cmp_lg_u32 s41, 0
    s_cbranch_scc1 L_l0_34
    s_add_u32 m0, s42, 90112
    s_add_u32 s43, s77, 90112
    buffer_load_dwordx4 v2, s[4:7], s43 offen sc1 lds
    buffer_load_dwordx4 v2, s[4:7], s43 offen offset:1024 sc1 lds
L_l0_34:
    v_mfma_f32_16x16x32_bf16 v[64:67], a[140:143], v[96:99], v[64:67]
    ds_read_b128 v[92:95], v1 offset:33792
    s_waitcnt lgkmcnt(4)
    v_mfma_f32_16x16x32_bf16 v[68:71], a[144:147], v[96:99], v[68:71]
    buffer_load_dwordx4 v[184:187], v1, s[4:7], s58 offen offset:3072 sc1
    v_mfma_f32_16x16x32_bf16 v[72:75], a[140:143], v[100:103], v[72:75]
    ds_read_b128 v[96:99], v1 offset:34816
    s_waitcnt vmcnt(9) lgkmcnt(4)
    v_mfma_f32_16x16x32_bf16 v[76:79], a[144:147], v[100:103], v[76:79]
    buffer_load_dwordx4 v[188:191], v1, s[4:7], s59 offen offset:3072 sc1
    v_mfma_f32_16x16x32_bf16 v[40:43], a[148:151], v[80:83], v[40:43]
    ds_read_b128 v[100:103], v1 offset:35840
    s_waitcnt lgkmcnt(4)
    v_mfma_f32_16x16x32_bf16 v[44:47], a[152:155], v[80:83], v[44:47]
    s_cmp_lg_u32 s41, 0
    s_cbranch_scc1 L_l0_35
    s_add_u32 m0, s42, 98304
    s_add_u32 s43, s77, 98304
    buffer_load_dwordx4 v2, s[4:7], s43 offen sc1 lds
    buffer_load_dwordx4 v2, s[4:7], s43 offen offset:1024 sc1 lds
L_l0_35:
    v_mfma_f32_16x16x32_bf16 v[48:51], a[148:151], v[84:87], v[48:51]
    ds_read_b128 v[80:83], v1 offset:36864
    s_waitcnt lgkmcnt(4)
    v_mfma_f32_16x16x32_bf16 v[52:55], a[152:155], v[84:87], v[52:55]
    s_barrier
    s_cmp_lg_u32 s41, 0
    s_cbranch_scc1 L_l0_36
    v_add_f32 v116, v116, v117
    v_add_f32 v116, v116, v118
    v_add_f32 v116, v116, v119
    v_add_f32 v116, v116, v120
    v_add_f32 v116, v116, v121
    v_add_f32 v116, v116, v122
    v_add_f32 v116, v116, v123
    v_add_f32 v116, v116, v124
    v_add_f32 v116, v116, v125
    v_add_f32 v116, v116, v126
    v_add_f32 v116, v116, v127
    v_add_f32 v116, v116, v128
    v_add_f32 v116, v116, v129
    v_add_f32 v116, v116, v130
    v_add_f32 v116, v116, v131
    v_add_f32 v116, v116, v132
    v_add_f32 v116, v116, v133
    v_add_f32 v116, v116, v134
    v_add_f32 v116, v116, v135
    v_lshrrev_b32 v136, 2, v9
    v_and_b32 v136, 511, v136
    v_add_u32 v136, 160768, v136
    ds_write_b32 v136, v116
    s_waitcnt lgkmcnt(0)
L_l0_36:
    v_mfma_f32_16x16x32_bf16 v[56:59], a[148:151], v[88:91], v[56:59]
    ds_read_b128 v[84:87], v1 offset:37888
    s_waitcnt lgkmcnt(4)
    v_mfma_f32_16x16x32_bf16 v[60:63], a[152:155], v[88:91], v[60:63]
    s_add_u32 s58, s58, 4096
    s_add_u32 s59, s59, 4096
    v_mfma_f32_16x16x32_bf16 v[64:67], a[148:151], v[92:95], v[64:67]
    ds_read_b128 v[88:91], v1 offset:38912
    s_waitcnt lgkmcnt(4)
    v_mfma_f32_16x16x32_bf16 v[68:71], a[152:155], v[92:95], v[68:71]
    buffer_load_dwordx4 v[192:195], v1, s[4:7], s58 offen offset:0 sc1
    v_mfma_f32_16x16x32_bf16 v[72:75], a[148:151], v[96:99], v[72:75]
    ds_read_b128 v[92:95], v1 offset:39936
    s_waitcnt vmcnt(9) lgkmcnt(4)
    v_mfma_f32_16x16x32_bf16 v[76:79], a[152:155], v[96:99], v[76:79]
    buffer_load_dwordx4 v[196:199], v1, s[4:7], s59 offen offset:0 sc1
    v_mfma_f32_16x16x32_bf16 v[40:43], a[156:159], v[100:103], v[40:43]
    ds_read_b128 v[96:99], v1 offset:40960
    s_waitcnt lgkmcnt(4)
    v_mfma_f32_16x16x32_bf16 v[44:47], a[160:163], v[100:103], v[44:47]
    v_pk_add_f32 v[104:105], v[104:105], v[106:107]
    v_mfma_f32_16x16x32_bf16 v[48:51], a[156:159], v[80:83], v[48:51]
    ds_read_b128 v[100:103], v1 offset:41984
    s_waitcnt lgkmcnt(4)
    v_mfma_f32_16x16x32_bf16 v[52:55], a[160:163], v[80:83], v[52:55]
    buffer_load_dwordx4 v[200:203], v1, s[4:7], s58 offen offset:1024 sc1
    v_mfma_f32_16x16x32_bf16 v[56:59], a[156:159], v[84:87], v[56:59]
    ds_read_b128 v[80:83], v1 offset:43008
    s_waitcnt lgkmcnt(4)
    v_mfma_f32_16x16x32_bf16 v[60:63], a[160:163], v[84:87], v[60:63]
    buffer_load_dwordx4 v[204:207], v1, s[4:7], s59 offen offset:1024 sc1
    v_mfma_f32_16x16x32_bf16 v[64:67], a[156:159], v[88:91], v[64:67]
    ds_read_b128 v[84:87], v1 offset:44032
    s_waitcnt lgkmcnt(4)
    v_mfma_f32_16x16x32_bf16 v[68:71], a[160:163], v[88:91], v[68:71]
    v_pk_add_f32 v[108:109], v[108:109], v[110:111]
    v_mov_b32 v106, v104
    v_mfma_f32_16x16x32_bf16 v[72:75], a[156:159], v[92:95], v[72:75]
    ds_read_b128 v[88:91], v1 offset:45056
    s_waitcnt vmcnt(10) lgkmcnt(4)
    v_mfma_f32_16x16x32_bf16 v[76:79], a[160:163], v[92:95], v[76:79]
    buffer_load_dwordx4 v[208:211], v1, s[4:7], s58 offen offset:2048 sc1
    v_mfma_f32_16x16x32_bf16 v[40:43], a[164:167], v[96:99], v[40:43]
    ds_read_b128 v[92:95], v1 offset:46080
    s_waitcnt lgkmcnt(4)
    v_mfma_f32_16x16x32_bf16 v[44:47], a[168:171], v[96:99], v[44:47]
    buffer_load_dwordx4 v[212:215], v1, s[4:7], s59 offen offset:2048 sc1
    v_mfma_f32_16x16x32_bf16 v[48:51], a[164:167], v[100:103], v[48:51]
    ds_read_b128 v[96:99], v1 offset:47104
    s_waitcnt lgkmcnt(4)
    v_mfma_f32_16x16x32_bf16 v[52:55], a[168:171], v[100:103], v[52:55]
    v_mov_b32 v107, v105
    v_mov_b32 v110, v108
    v_mfma_f32_16x16x32_bf16 v[56:59], a[164:167], v[80:83], v[56:59]
    ds_read_b128 v[100:103], v1 offset:48128
    s_waitcnt lgkmcnt(4)
    v_mfma_f32_16x16x32_bf16 v[60:63], a[168:171], v[80:83], v[60:63]
    buffer_load_dwordx4 v[216:219], v1, s[4:7], s58 offen offset:3072 sc1
    v_mfma_f32_16x16x32_bf16 v[64:67], a[164:167], v[84:87], v[64:67]
    ds_read_b128 v[80:83], v1 offset:49152
    s_waitcnt lgkmcnt(4)
    v_mfma_f32_16x16x32_bf16 v[68:71], a[168:171], v[84:87], v[68:71]
    buffer_load_dwordx4 v[220:223], v1, s[4:7], s59 offen offset:3072 sc1
    v_mfma_f32_16x16x32_bf16 v[72:75], a[164:167], v[88:91], v[72:75]
    ds_read_b128 v[84:87], v1 offset:50176
    s_waitcnt vmcnt(12) lgkmcnt(4)
    v_mfma_f32_16x16x32_bf16 v[76:79], a[168:171], v[88:91], v[76:79]
    s_add_u32 s58, s58, 4096
    s_add_u32 s59, s59, 4096
    v_mfma_f32_16x16x32_bf16 v[40:43], a[172:175], v[92:95], v[40:43]
    ds_read_b128 v[88:91], v1 offset:51200
    s_waitcnt lgkmcnt(4)
    v_mfma_f32_16x16x32_bf16 v[44:47], v[172:175], v[92:95], v[44:47]
    buffer_load_dwordx4 v[224:227], v1, s[4:7], s58 offen offset:0 sc1
    v_mfma_f32_16x16x32_bf16 v[48:51], a[172:175], v[96:99], v[48:51]
    ds_read_b128 v[92:95], v1 offset:52224
    s_waitcnt lgkmcnt(4)
    v_mfma_f32_16x16x32_bf16 v[52:55], v[172:175], v[96:99], v[52:55]
    buffer_load_dwordx4 v[228:231], v1, s[4:7], s59 offen offset:0 sc1
    v_mfma_f32_16x16x32_bf16 v[56:59], a[172:175], v[100:103], v[56:59]
    ds_read_b128 v[96:99], v1 offset:53248
    s_waitcnt lgkmcnt(4)
    v_mfma_f32_16x16x32_bf16 v[60:63], v[172:175], v[100:103], v[60:63]
    s_barrier
    v_mfma_f32_16x16x32_bf16 v[64:67], a[172:175], v[80:83], v[64:67]
    ds_read_b128 v[100:103], v1 offset:54272
    s_waitcnt lgkmcnt(4)
    v_mfma_f32_16x16x32_bf16 v[68:71], v[172:175], v[80:83], v[68:71]
    buffer_load_dwordx4 v[232:235], v1, s[4:7], s58 offen offset:1024 sc1
    v_mfma_f32_16x16x32_bf16 v[72:75], a[172:175], v[84:87], v[72:75]
    ds_read_b128 v[80:83], v1 offset:55296
    s_waitcnt vmcnt(13) lgkmcnt(4)
    v_mfma_f32_16x16x32_bf16 v[76:79], v[172:175], v[84:87], v[76:79]
    buffer_load_dwordx4 v[236:239], v1, s[4:7], s59 offen offset:1024 sc1
    v_mfma_f32_16x16x32_bf16 v[40:43], v[176:179], v[88:91], v[40:43]
    ds_read_b128 v[84:87], v1 offset:56320
    s_waitcnt lgkmcnt(4)
    v_mfma_f32_16x16x32_bf16 v[44:47], v[180:183], v[88:91], v[44:47]
    v_mov_b32 v111, v109
    v_permlane16_swap_b32 v104, v106
    v_mfma_f32_16x16x32_bf16 v[48:51], v[176:179], v[92:95], v[48:51]
    ds_read_b128 v[88:91], v1 offset:57344
    s_waitcnt lgkmcnt(4)
    v_mfma_f32_16x16x32_bf16 v[52:55], v[180:183], v[92:95], v[52:55]
    buffer_load_dwordx4 v[240:243], v1, s[4:7], s58 offen offset:2048 sc1
    v_mfma_f32_16x16x32_bf16 v[56:59], v[176:179], v[96:99], v[56:59]
    ds_read_b128 v[92:95], v1 offset:58368
    s_waitcnt lgkmcnt(4)
    v_mfma_f32_16x16x32_bf16 v[60:63], v[180:183], v[96:99], v[60:63]
    buffer_load_dwordx4 v[244:247], v1, s[4:7], s59 offen offset:2048 sc1
    v_mfma_f32_16x16x32_bf16 v[64:67], v[176:179], v[100:103], v[64:67]
    ds_read_b128 v[96:99], v1 offset:59392
    s_waitcnt lgkmcnt(4)
    v_mfma_f32_16x16x32_bf16 v[68:71], v[180:183], v[100:103], v[68:71]
    v_permlane16_swap_b32 v105, v107
    v_permlane16_swap_b32 v108, v110
    v_mfma_f32_16x16x32_bf16 v[72:75], v[176:179], v[80:83], v[72:75]
    ds_read_b128 v[100:103], v1 offset:60416
    s_waitcnt vmcnt(14) lgkmcnt(4)
    v_mfma_f32_16x16x32_bf16 v[76:79], v[180:183], v[80:83], v[76:79]
    buffer_load_dwordx4 v[248:251], v1, s[4:7], s58 offen offset:3072 sc1
    v_mfma_f32_16x16x32_bf16 v[40:43], v[184:187], v[84:87], v[40:43]
    ds_read_b128 v[80:83], v1 offset:61440
    s_waitcnt lgkmcnt(4)
    v_mfma_f32_16x16x32_bf16 v[44:47], v[188:191], v[84:87], v[44:47]
    buffer_load_dwordx4 v[252:255], v1, s[4:7], s59 offen offset:3072 sc1
    v_mfma_f32_16x16x32_bf16 v[48:51], v[184:187], v[88:91], v[48:51]
    ds_read_b128 v[84:87], v1 offset:62464
    s_waitcnt lgkmcnt(4)
    v_mfma_f32_16x16x32_bf16 v[52:55], v[188:191], v[88:91], v[52:55]
    v_permlane16_swap_b32 v109, v111
    v_add_f32 v104, v104, v106
    v_mfma_f32_16x16x32_bf16 v[56:59], v[184:187], v[92:95], v[56:59]
    ds_read_b128 v[88:91], v1 offset:63488
    s_waitcnt lgkmcnt(4)
    v_mfma_f32_16x16x32_bf16 v[60:63], v[188:191], v[92:95], v[60:63]
    v_add_f32 v105, v105, v107
    v_add_f32 v108, v108, v110
    v_mfma_f32_16x16x32_bf16 v[64:67], v[184:187], v[96:99], v[64:67]
    ds_read_b128 v[92:95], v1 offset:64512
    s_waitcnt lgkmcnt(4)
    v_mfma_f32_16x16x32_bf16 v[68:71], v[188:191], v[96:99], v[68:71]
    v_add_f32 v109, v109, v111
    v_mov_b32 v106, v104
    v_mfma_f32_16x16x32_bf16 v[72:75], v[184:187], v[100:103], v[72:75]
    ds_read_b128 v[96:99], v3 offset:0
    s_waitcnt vmcnt(14) lgkmcnt(4)
    v_mfma_f32_16x16x32_bf16 v[76:79], v[188:191], v[100:103], v[76:79]
    v_mov_b32 v107, v105
    v_mov_b32 v110, v108
    v_mfma_f32_16x16x32_bf16 v[40:43], v[192:195], v[80:83], v[40:43]
    ds_read_b128 v[100:103], v3 offset:1024
    s_waitcnt lgkmcnt(4)
    v_mfma_f32_16x16x32_bf16 v[44:47], v[196:199], v[80:83], v[44:47]
    v_mov_b32 v111, v109
    v_permlane32_swap_b32 v104, v106
    v_mfma_f32_16x16x32_bf16 v[48:51], v[192:195], v[84:87], v[48:51]
    ds_read_b128 v[80:83], v3 offset:2048
    s_waitcnt lgkmcnt(4)
    v_mfma_f32_16x16x32_bf16 v[52:55], v[196:199], v[84:87], v[52:55]
    v_permlane32_swap_b32 v105, v107
    v_permlane32_swap_b32 v108, v110
    v_mfma_f32_16x16x32_bf16 v[56:59], v[192:195], v[88:91], v[56:59]
    ds_read_b128 v[84:87], v3 offset:3072
    s_waitcnt lgkmcnt(4)
    v_mfma_f32_16x16x32_bf16 v[60:63], v[196:199], v[88:91], v[60:63]
    v_permlane32_swap_b32 v109, v111
    v_add_f32 v104, v104, v106
    v_mfma_f32_16x16x32_bf16 v[64:67], v[192:195], v[92:95], v[64:67]
    ds_read_b128 v[88:91], v3 offset:4096
    s_waitcnt lgkmcnt(4)
    v_mfma_f32_16x16x32_bf16 v[68:71], v[196:199], v[92:95], v[68:71]
    s_barrier
    s_cmp_lg_u32 s41, 0
    s_cbranch_scc1 L_l0_37
    s_cmp_eq_u32 s90, 1
    s_cbranch_scc1 L_crit_38
    s_mov_b32 s88, 0
    s_nop 1
L_oloop_39:
    s_cmp_eq_u32 s79, 0
    s_cbranch_scc1 L_oskip_40
    ds_read_b64_tr_b16 a[0:1], v138 offset:0
    ds_read_b64_tr_b16 a[2:3], v138 offset:4096
    ds_read_b64_tr_b16 a[4:5], v138 offset:32
    ds_read_b64_tr_b16 a[6:7], v138 offset:4128
    ds_read_b64_tr_b16 a[8:9], v138 offset:64
    ds_read_b64_tr_b16 a[10:11], v138 offset:4160
    ds_read_b64_tr_b16 a[12:13], v138 offset:96
    ds_read_b64_tr_b16 a[14:15], v138 offset:4192
    ds_read_b64_tr_b16 a[16:17], v138 offset:128
    ds_read_b64_tr_b16 a[18:19], v138 offset:4224
    ds_read_b64_tr_b16 a[20:21], v138 offset:160
    ds_read_b64_tr_b16 a[22:23], v138 offset:4256
    ds_read_b64_tr_b16 a[24:25], v138 offset:192
    ds_read_b64_tr_b16 a[26:27], v138 offset:4288
    ds_read_b64_tr_b16 a[28:29], v138 offset:224
    ds_read_b64_tr_b16 a[30:31], v138 offset:4320
    s_cmp_eq_u32 s79, 7
    s_cselect_b32 s89, 2, 1
    s_lshl_b32 s89, s89, 10
    s_waitcnt lgkmcnt(0)
    v_mfma_f32_16x16x32_bf16 a[32:35], a[64:67], a[0:3], 0
    v_mfma_f32_16x16x32_bf16 a[36:39], a[64:67], a[4:7], 0
    v_mfma_f32_16x16x32_bf16 a[40:43], a[64:67], a[8:11], 0
    v_mfma_f32_16x16x32_bf16 a[44:47], a[64:67], a[12:15], 0
    v_mfma_f32_16x16x32_bf16 a[48:51], a[64:67], a[16:19], 0
    v_mfma_f32_16x16x32_bf16 a[52:55], a[64:67], a[20:23], 0
    v_mfma_f32_16x16x32_bf16 a[56:59], a[64:67], a[24:27], 0
    v_mfma_f32_16x16x32_bf16 a[60:63], a[64:67], a[28:31], 0
    buffer_store_dwordx4 a[0:3], v1, s[4:7], s78 offen sc1
    s_add_u32 s78, s78, s89
    buffer_store_dwordx4 a[4:7], v1, s[4:7], s78 offen sc1
    s_add_u32 s78, s78, s89
    buffer_store_dwordx4 a[8:11], v1, s[4:7], s78 offen sc1
    s_add_u32 s78, s78, s89
    buffer_store_dwordx4 a[12:15], v1, s[4:7], s78 offen sc1
    s_add_u32 s78, s78, s89
    buffer_store_dwordx4 a[16:19], v1, s[4:7], s78 offen sc1
    s_add_u32 s78, s78, s89
    s_cmp_eq_u32 s79, 5
    s_cbranch_scc1 L_stdone_41
    s_add_u32 s78, s78, s91
    buffer_store_dwordx4 a[20:23], v1, s[4:7], s78 offen sc1
    s_add_u32 s78, s78, s89
    buffer_store_dwordx4 a[24:27], v1, s[4:7], s78 offen sc1
    s_add_u32 s78, s78, s89
    s_cmp_eq_u32 s79, 7
    s_cbranch_scc1 L_stdone_41
    buffer_store_dwordx4 a[28:31], v1, s[4:7], s78 offen sc1
    s_add_u32 s78, s78, s89
L_stdone_41:
    s_cmp_eq_u32 s80, -1
    s_cbranch_scc1 L_oskip_40
    s_nop 7
    v_accvgpr_read_b32 v142, a32
    v_accvgpr_read_b32 v144, a36
    s_lshl_b64 vcc, s[68:69], 16
    v_cndmask_b32 v142, v142, v144, vcc
    v_accvgpr_read_b32 v144, a40
    s_lshl_b64 vcc, s[68:69], 32
    v_cndmask_b32 v142, v142, v144, vcc
    v_accvgpr_read_b32 v144, a44
    s_lshl_b64 vcc, s[68:69], 48
    v_cndmask_b32 v142, v142, v144, vcc
    buffer_store_dword v142, v139, s[4:7], s80 offen offset:0 sc1
    v_accvgpr_read_b32 v143, a48
    v_accvgpr_read_b32 v144, a52
    s_lshl_b64 vcc, s[68:69], 16
    v_cndmask_b32 v143, v143, v144, vcc
    v_accvgpr_read_b32 v144, a56
    s_lshl_b64 vcc, s[68:69], 32
    v_cndmask_b32 v143, v143, v144, vcc
    v_accvgpr_read_b32 v144, a60
    s_lshl_b64 vcc, s[68:69], 48
    v_cndmask_b32 v143, v143, v144, vcc
    buffer_store_dword v143, v139, s[4:7], s80 offen offset:256 sc1
L_oskip_40:
    s_mov_b32 s78, s81
    s_mov_b32 s79, s82
    s_mov_b32 s80, s83
    v_add_u32 v138, 8192, v138
    s_add_u32 s88, s88, 1
    s_cmp_lt_u32 s88, 2
    s_nop 7
    s_cbranch_scc1 L_oloop_39
L_crit_38:
L_l0_37:
    v_mfma_f32_16x16x32_bf16 v[72:75], v[192:195], v[96:99], v[72:75]
    ds_read_b128 v[92:95], v3 offset:5120
    s_waitcnt vmcnt(12) lgkmcnt(4)
    v_mfma_f32_16x16x32_bf16 v[76:79], v[196:199], v[96:99], v[76:79]
    v_add_f32 v105, v105, v107
    v_add_f32 v108, v108, v110
    v_mfma_f32_16x16x32_bf16 v[40:43], v[200:203], v[100:103], v[40:43]
    ds_read_b128 v[96:99], v3 offset:6144
    s_waitcnt lgkmcnt(4)
    v_mfma_f32_16x16x32_bf16 v[44:47], v[204:207], v[100:103], v[44:47]
    v_add_f32 v109, v109, v111
    v_mul_f32 v104, 0xbacccccd, v104
    v_mfma_f32_16x16x32_bf16 v[48:51], v[200:203], v[80:83], v[48:51]
    ds_read_b128 v[100:103], v3 offset:7168
    s_waitcnt lgkmcnt(4)
    v_mfma_f32_16x16x32_bf16 v[52:55], v[204:207], v[80:83], v[52:55]
    v_mul_f32 v105, 0x3acccccd, v105
    v_mul_f32 v108, 0xbacccccd, v108
    v_mfma_f32_16x16x32_bf16 v[56:59], v[200:203], v[84:87], v[56:59]
    ds_read_b128 v[80:83], v3 offset:8192
    s_waitcnt lgkmcnt(4)
    v_mfma_f32_16x16x32_bf16 v[60:63], v[204:207], v[84:87], v[60:63]
    v_mul_f32 v109, 0x3acccccd, v109
    v_fma_f32 v105, -v104, v104, v105
    v_mfma_f32_16x16x32_bf16 v[64:67], v[200:203], v[88:91], v[64:67]
    ds_read_b128 v[84:87], v3 offset:9216
    s_waitcnt lgkmcnt(4)
    v_mfma_f32_16x16x32_bf16 v[68:71], v[204:207], v[88:91], v[68:71]
    v_fma_f32 v109, -v108, v108, v109
    v_max_f32 v105, 0, v105
    v_mfma_f32_16x16x32_bf16 v[72:75], v[200:203], v[92:95], v[72:75]
    ds_read_b128 v[88:91], v3 offset:10240
    s_waitcnt vmcnt(10) lgkmcnt(4)
    v_mfma_f32_16x16x32_bf16 v[76:79], v[204:207], v[92:95], v[76:79]
    v_max_f32 v109, 0, v109
    v_add_f32 v105, 0x3727c5ac, v105
    v_mfma_f32_16x16x32_bf16 v[40:43], v[208:211], v[96:99], v[40:43]
    ds_read_b128 v[92:95], v3 offset:11264
    s_waitcnt lgkmcnt(4)
    v_mfma_f32_16x16x32_bf16 v[44:47], v[212:215], v[96:99], v[44:47]
    v_add_f32 v109, 0x3727c5ac, v109
    v_mfma_f32_16x16x32_bf16 v[48:51], v[208:211], v[100:103], v[48:51]
    ds_read_b128 v[96:99], v3 offset:12288
    s_waitcnt lgkmcnt(4)
    v_mfma_f32_16x16x32_bf16 v[52:55], v[212:215], v[100:103], v[52:55]
    v_rsq_f32 v105, v105
    v_mfma_f32_16x16x32_bf16 v[56:59], v[208:211], v[80:83], v[56:59]
    ds_read_b128 v[100:103], v3 offset:13312
    s_waitcnt lgkmcnt(4)
    v_mfma_f32_16x16x32_bf16 v[60:63], v[212:215], v[80:83], v[60:63]
    v_rsq_f32 v109, v109
    v_mfma_f32_16x16x32_bf16 v[64:67], v[208:211], v[84:87], v[64:67]
    ds_read_b128 v[80:83], v3 offset:14336
    s_waitcnt lgkmcnt(4)
    v_mfma_f32_16x16x32_bf16 v[68:71], v[212:215], v[84:87], v[68:71]
    v_and_b32 v112, 15, v0
    s_lshl_b32 s100, s18, 8
    v_mfma_f32_16x16x32_bf16 v[72:75], v[208:211], v[88:91], v[72:75]
    ds_read_b128 v[84:87], v3 offset:15360
    s_waitcnt vmcnt(8) lgkmcnt(4)
    v_mfma_f32_16x16x32_bf16 v[76:79], v[212:215], v[88:91], v[76:79]
    s_add_u32 s100, s100, 159744
    v_lshl_add_u32 v112, v112, 2, s100
    v_mfma_f32_16x16x32_bf16 v[40:43], v[216:219], v[92:95], v[40:43]
    ds_read_b128 v[88:91], v3 offset:16384
    s_waitcnt lgkmcnt(4)
    v_mfma_f32_16x16x32_bf16 v[44:47], v[220:223], v[92:95], v[44:47]
    ds_write_b32 v112, v104 offset:0
    ds_write_b32 v112, v105 offset:128
    v_mfma_f32_16x16x32_bf16 v[48:51], v[216:219], v[96:99], v[48:51]
    ds_read_b128 v[92:95], v3 offset:17408
    s_waitcnt lgkmcnt(6)
    v_mfma_f32_16x16x32_bf16 v[52:55], v[220:223], v[96:99], v[52:55]
    ds_write_b32 v112, v108 offset:64
    ds_write_b32 v112, v109 offset:192
    v_mfma_f32_16x16x32_bf16 v[56:59], v[216:219], v[100:103], v[56:59]
    ds_read_b128 v[96:99], v3 offset:18432
    s_waitcnt lgkmcnt(8)
    v_mfma_f32_16x16x32_bf16 v[60:63], v[220:223], v[100:103], v[60:63]
    v_mfma_f32_16x16x32_bf16 v[64:67], v[216:219], v[80:83], v[64:67]
    ds_read_b128 v[100:103], v3 offset:19456
    s_waitcnt lgkmcnt(8)
    v_mfma_f32_16x16x32_bf16 v[68:71], v[220:223], v[80:83], v[68:71]
    v_mfma_f32_16x16x32_bf16 v[72:75], v[216:219], v[84:87], v[72:75]
    ds_read_b128 v[80:83], v3 offset:20480
    s_waitcnt vmcnt(6) lgkmcnt(8)
    v_mfma_f32_16x16x32_bf16 v[76:79], v[220:223], v[84:87], v[76:79]
    s_barrier
    s_add_u32 m0, s42, 106496
    s_add_u32 s43, s77, 106496
    buffer_load_dwordx4 v2, s[4:7], s43 offen sc1 lds
    buffer_load_dwordx4 v2, s[4:7], s43 offen offset:1024 sc1 lds
    s_add_u32 m0, s42, 114688
    s_add_u32 s43, s77, 114688
    buffer_load_dwordx4 v2, s[4:7], s43 offen sc1 lds
    buffer_load_dwordx4 v2, s[4:7], s43 offen offset:1024 sc1 lds
    s_add_u32 m0, s42, 122880
    s_add_u32 s43, s77, 122880
    buffer_load_dwordx4 v2, s[4:7], s43 offen sc1 lds
    buffer_load_dwordx4 v2, s[4:7], s43 offen offset:1024 sc1 lds
    s_add_u32 m0, s42, 131072
    s_add_u32 s43, s77, 131072
    buffer_load_dwordx4 v2, s[4:7], s43 offen sc1 lds
    buffer_load_dwordx4 v2, s[4:7], s43 offen offset:1024 sc1 lds
    s_add_u32 m0, s42, 139264
    s_add_u32 s43, s77, 139264
    buffer_load_dwordx4 v2, s[4:7], s43 offen sc1 lds
    buffer_load_dwordx4 v2, s[4:7], s43 offen offset:1024 sc1 lds
    v_mfma_f32_16x16x32_bf16 v[40:43], v[224:227], v[88:91], v[40:43]
    ds_read_b128 v[84:87], v3 offset:21504
    s_waitcnt lgkmcnt(6)
    v_mfma_f32_16x16x32_bf16 v[44:47], v[228:231], v[88:91], v[44:47]
    v_mfma_f32_16x16x32_bf16 v[48:51], v[224:227], v[92:95], v[48:51]
    ds_read_b128 v[88:91], v3 offset:22528
    s_waitcnt lgkmcnt(4)
    v_mfma_f32_16x16x32_bf16 v[52:55], v[228:231], v[92:95], v[52:55]
    v_mfma_f32_16x16x32_bf16 v[56:59], v[224:227], v[96:99], v[56:59]
    ds_read_b128 v[92:95], v3 offset:23552
    s_waitcnt lgkmcnt(4)
    v_mfma_f32_16x16x32_bf16 v[60:63], v[228:231], v[96:99], v[60:63]
    s_lshl_b32 s3, s18, 8
    s_add_u32 s3, s3, 159744
    v_mfma_f32_16x16x32_bf16 v[64:67], v[224:227], v[100:103], v[64:67]
    ds_read_b128 v[96:99], v3 offset:24576
    s_waitcnt lgkmcnt(4)
    v_mfma_f32_16x16x32_bf16 v[68:71], v[228:231], v[100:103], v[68:71]
    v_and_b32 v10, 48, v0
    v_add_u32 v10, s3, v10
    v_mfma_f32_16x16x32_bf16 v[72:75], v[224:227], v[80:83], v[72:75]
    ds_read_b128 v[100:103], v3 offset:25600
    s_waitcnt vmcnt(14) lgkmcnt(4)
    v_mfma_f32_16x16x32_bf16 v[76:79], v[228:231], v[80:83], v[76:79]
    v_and_b32 v11, 15, v0
    v_lshl_add_u32 v11, v11, 2, s3
    v_mfma_f32_16x16x32_bf16 v[40:43], v[232:235], v[84:87], v[40:43]
    ds_read_b128 v[80:83], v3 offset:26624
    s_waitcnt lgkmcnt(4)
    v_mfma_f32_16x16x32_bf16 v[44:47], v[236:239], v[84:87], v[44:47]
    v_and_b32 v12, 15, v0
    v_lshlrev_b32 v12, 2, v12
    v_mfma_f32_16x16x32_bf16 v[48:51], v[232:235], v[88:91], v[48:51]
    ds_read_b128 v[84:87], v3 offset:27648
    s_waitcnt lgkmcnt(4)
    v_mfma_f32_16x16x32_bf16 v[52:55], v[236:239], v[88:91], v[52:55]
    v_add_u32 v12, 160768, v12
    v_and_b32 v13, 48, v0
    v_mfma_f32_16x16x32_bf16 v[56:59], v[232:235], v[92:95], v[56:59]
    ds_read_b128 v[88:91], v3 offset:28672
    s_waitcnt lgkmcnt(4)
    v_mfma_f32_16x16x32_bf16 v[60:63], v[236:239], v[92:95], v[60:63]
    v_add_u32 v13, 160768, v13
    ds_read_b128 v[104:107], v10 offset:0
    v_mfma_f32_16x16x32_bf16 v[64:67], v[232:235], v[96:99], v[64:67]
    ds_read_b128 v[92:95], v3 offset:29696
    s_waitcnt lgkmcnt(5)
    v_mfma_f32_16x16x32_bf16 v[68:71], v[236:239], v[96:99], v[68:71]
    ds_read_b128 v[112:115], v10 offset:128
    ds_read_b128 v[108:111], v10 offset:64
    v_mfma_f32_16x16x32_bf16 v[72:75], v[232:235], v[100:103], v[72:75]
    ds_read_b128 v[96:99], v3 offset:30720
    s_waitcnt vmcnt(12) lgkmcnt(7)
    v_mfma_f32_16x16x32_bf16 v[76:79], v[236:239], v[100:103], v[76:79]
    ds_read_b128 v[116:119], v10 offset:192
    ds_read_b32 v128, v12 offset:0
    v_mfma_f32_16x16x32_bf16 v[40:43], v[240:243], v[80:83], v[40:43]
    ds_read_b128 v[100:103], v3 offset:31744
    s_waitcnt lgkmcnt(9)
    v_mfma_f32_16x16x32_bf16 v[44:47], v[244:247], v[80:83], v[44:47]
    ds_read_b32 v130, v12 offset:64
    ds_read_b32 v132, v12 offset:128
    v_mfma_f32_16x16x32_bf16 v[48:51], v[240:243], v[84:87], v[48:51]
    ds_read_b128 v[80:83], v3 offset:32768
    s_waitcnt lgkmcnt(11)
    v_mfma_f32_16x16x32_bf16 v[52:55], v[244:247], v[84:87], v[52:55]
    ds_read_b32 v134, v12 offset:192
    ds_read_b32 v136, v12 offset:256
    v_mfma_f32_16x16x32_bf16 v[56:59], v[240:243], v[88:91], v[56:59]
    ds_read_b128 v[84:87], v3 offset:33792
    s_waitcnt lgkmcnt(12)
    v_mfma_f32_16x16x32_bf16 v[60:63], v[244:247], v[88:91], v[60:63]
    s_mul_i32 s54, s18, 9216
    s_add_u32 s54, s54, 16384
    v_mfma_f32_16x16x32_bf16 v[64:67], v[240:243], v[92:95], v[64:67]
    ds_read_b128 v[88:91], v3 offset:34816
    s_waitcnt lgkmcnt(10)
    v_mfma_f32_16x16x32_bf16 v[68:71], v[244:247], v[92:95], v[68:71]
    v_add_u32 v16, s54, v1
    s_mul_i32 s52, s41, 1048576
    v_mfma_f32_16x16x32_bf16 v[72:75], v[240:243], v[96:99], v[72:75]
    ds_read_b128 v[92:95], v3 offset:35840
    s_waitcnt vmcnt(10) lgkmcnt(8)
    v_mfma_f32_16x16x32_bf16 v[76:79], v[244:247], v[96:99], v[76:79]
    s_lshl_b32 s54, s17, 16
    s_add_u32 s52, s52, s54
    v_mfma_f32_16x16x32_bf16 v[40:43], v[248:251], v[100:103], v[40:43]
    s_waitcnt lgkmcnt(5)
    v_mfma_f32_16x16x32_bf16 v[44:47], v[252:255], v[100:103], v[44:47]
    s_add_u32 s52, s52, 1146880
    s_lshl_b32 s53, s16, 12
    v_mfma_f32_16x16x32_bf16 v[48:51], v[248:251], v[80:83], v[48:51]
    s_waitcnt lgkmcnt(2)
    v_mfma_f32_16x16x32_bf16 v[52:55], v[252:255], v[80:83], v[52:55]
    s_add_u32 s53, s53, s52
    v_lshlrev_b32 v14, 1, v9
    v_mfma_f32_16x16x32_bf16 v[56:59], v[248:251], v[84:87], v[56:59]
    s_waitcnt lgkmcnt(1)
    v_mfma_f32_16x16x32_bf16 v[60:63], v[252:255], v[84:87], v[60:63]
    v_add_u32 v14, 53248, v14
    v_mov_b32 v15, 0x3f803f80
    v_mfma_f32_16x16x32_bf16 v[64:67], v[248:251], v[88:91], v[64:67]
    s_waitcnt lgkmcnt(0)
    v_mfma_f32_16x16x32_bf16 v[68:71], v[252:255], v[88:91], v[68:71]
    v_bfrev_b32 v17, 1
    v_cmp_gt_u32 vcc, 3360, v9
    v_mfma_f32_16x16x32_bf16 v[72:75], v[248:251], v[92:95], v[72:75]
    s_nop 0
    v_cndmask_b32 v17, v17, v9, vcc
    v_mfma_f32_16x16x32_bf16 v[76:79], v[252:255], v[92:95], v[76:79]
    v_mul_f32 v120, 0x3fb8aa3b, v112
    v_mul_f32 v121, 0x3fb8aa3b, v113
    v_mul_f32 v122, 0x3fb8aa3b, v114
    v_mul_f32 v123, 0x3fb8aa3b, v115
    v_mul_f32 v124, 0x3fb8aa3b, v116
    v_mul_f32 v125, 0x3fb8aa3b, v117
    v_mul_f32 v126, 0x3fb8aa3b, v118
    v_mul_f32 v127, 0x3fb8aa3b, v119
    s_cmp_lg_u32 s41, 0
    s_cbranch_scc1 L_l0_42
    s_waitcnt vmcnt(0)
L_l0_42:
    s_waitcnt lgkmcnt(0)
    s_barrier
    s_cmp_lg_u32 s41, 0
    s_cbranch_scc1 L_l0_43
    s_cmp_lg_u32 s18, 0
    s_cbranch_scc1 L_noarr_44
    v_mov_b32 v19, 1
    s_mov_b64 exec, 4
    buffer_atomic_add v19, v5, s[4:7], 0 offen sc1
    s_mov_b64 exec, -1
L_noarr_44:
L_l0_43:
    v_pk_fma_f32 v[40:41], v[104:105], v[128:129], v[40:41] op_sel_hi:[1,0,1]
    v_pk_fma_f32 v[42:43], v[106:107], v[128:129], v[42:43] op_sel_hi:[1,0,1]
    v_pk_fma_f32 v[44:45], v[108:109], v[128:129], v[44:45] op_sel_hi:[1,0,1]
    v_pk_fma_f32 v[46:47], v[110:111], v[128:129], v[46:47] op_sel_hi:[1,0,1]
    v_pk_fma_f32 v[48:49], v[104:105], v[130:131], v[48:49] op_sel_hi:[1,0,1]
    v_pk_fma_f32 v[50:51], v[106:107], v[130:131], v[50:51] op_sel_hi:[1,0,1]
    v_pk_fma_f32 v[52:53], v[108:109], v[130:131], v[52:53] op_sel_hi:[1,0,1]
    s_add_u32 m0, s42, 0
    s_add_u32 s43, s77, 147456
    buffer_load_dwordx4 v2, s[4:7], s43 offen sc1 lds
    v_pk_fma_f32 v[54:55], v[110:111], v[130:131], v[54:55] op_sel_hi:[1,0,1]
    v_pk_fma_f32 v[56:57], v[104:105], v[132:133], v[56:57] op_sel_hi:[1,0,1]
    v_pk_fma_f32 v[58:59], v[106:107], v[132:133], v[58:59] op_sel_hi:[1,0,1]
    v_pk_fma_f32 v[60:61], v[108:109], v[132:133], v[60:61] op_sel_hi:[1,0,1]
    v_pk_fma_f32 v[62:63], v[110:111], v[132:133], v[62:63] op_sel_hi:[1,0,1]
    v_pk_fma_f32 v[64:65], v[104:105], v[134:135], v[64:65] op_sel_hi:[1,0,1]
    v_pk_fma_f32 v[66:67], v[106:107], v[134:135], v[66:67] op_sel_hi:[1,0,1]
    buffer_load_dwordx4 v2, s[4:7], s43 offen offset:1024 sc1 lds
    v_pk_fma_f32 v[68:69], v[108:109], v[134:135], v[68:69] op_sel_hi:[1,0,1]
    v_pk_fma_f32 v[70:71], v[110:111], v[134:135], v[70:71] op_sel_hi:[1,0,1]
    v_pk_fma_f32 v[72:73], v[104:105], v[136:137], v[72:73] op_sel_hi:[1,0,1]
    v_pk_fma_f32 v[74:75], v[106:107], v[136:137], v[74:75] op_sel_hi:[1,0,1]
    v_pk_fma_f32 v[76:77], v[108:109], v[136:137], v[76:77] op_sel_hi:[1,0,1]
    v_pk_fma_f32 v[78:79], v[110:111], v[136:137], v[78:79] op_sel_hi:[1,0,1]
    v_pk_mul_f32 v[164:165], v[56:57], v[112:113]
    s_add_u32 m0, s42, 8192
    s_add_u32 s43, s77, 155648
    buffer_load_dwordx4 v2, s[4:7], s43 offen sc1 lds
    v_pk_mul_f32 v[166:167], v[58:59], v[114:115]
    v_pk_mul_f32 v[168:169], v[60:61], v[116:117]
    v_pk_mul_f32 v[170:171], v[62:63], v[118:119]
    v_cvt_pk_bf16_f32 v152, v164, v165
    v_cvt_pk_bf16_f32 v153, v166, v167
    v_cvt_pk_bf16_f32 v154, v168, v169
    v_cvt_pk_bf16_f32 v155, v170, v171
    buffer_load_dwordx4 v2, s[4:7], s43 offen offset:1024 sc1 lds
    v_pk_mul_f32 v[164:165], v[64:65], v[112:113]
    v_pk_mul_f32 v[166:167], v[66:67], v[114:115]
    v_pk_mul_f32 v[168:169], v[68:69], v[116:117]
    v_pk_mul_f32 v[170:171], v[70:71], v[118:119]
    v_cvt_pk_bf16_f32 v156, v164, v165
    v_cvt_pk_bf16_f32 v157, v166, v167
    v_cvt_pk_bf16_f32 v158, v168, v169
    v_cvt_pk_bf16_f32 v159, v170, v171
    v_pk_mul_f32 v[164:165], v[72:73], v[112:113]
    v_pk_mul_f32 v[166:167], v[74:75], v[114:115]
    v_pk_mul_f32 v[168:169], v[76:77], v[116:117]
    v_pk_mul_f32 v[170:171], v[78:79], v[118:119]
    v_cvt_pk_bf16_f32 v160, v164, v165
    v_cvt_pk_bf16_f32 v161, v166, v167
    v_cvt_pk_bf16_f32 v162, v168, v169
    v_cvt_pk_bf16_f32 v163, v170, v171
    v_cndmask_b32 v152, v152, v15, s[66:67]
    v_cndmask_b32 v153, v153, v15, s[66:67]
    v_cndmask_b32 v154, v154, v15, s[66:67]
    v_cndmask_b32 v155, v155, v15, s[66:67]
    v_pk_fma_f32 v[164:165], v[40:41], v[112:113], s[64:65]
    v_pk_fma_f32 v[166:167], v[42:43], v[114:115], s[64:65]
    v_pk_fma_f32 v[168:169], v[44:45], v[116:117], s[64:65]
    v_pk_fma_f32 v[170:171], v[46:47], v[118:119], s[64:65]
    v_pk_mul_f32 v[40:41], v[40:41], v[120:121]
    v_pk_mul_f32 v[42:43], v[42:43], v[122:123]
    v_pk_mul_f32 v[44:45], v[44:45], v[124:125]
    v_pk_mul_f32 v[46:47], v[46:47], v[126:127]
    v_exp_f32_e64 v40, v40 clamp
    v_max_f32 v164, s64, v164
    v_exp_f32_e64 v41, v41 clamp
    v_max_f32 v165, s64, v165
    v_exp_f32_e64 v42, v42 clamp
    v_max_f32 v166, s64, v166
    v_exp_f32_e64 v43, v43 clamp
    v_max_f32 v167, s64, v167
    v_exp_f32_e64 v44, v44 clamp
    v_max_f32 v168, s64, v168
    v_exp_f32_e64 v45, v45 clamp
    v_max_f32 v169, s64, v169
    v_exp_f32_e64 v46, v46 clamp
    v_max_f32 v170, s64, v170
    v_exp_f32_e64 v47, v47 clamp
    v_max_f32 v171, s64, v171
    v_pk_add_f32 v[40:41], v[40:41], v[164:165]
    v_pk_add_f32 v[42:43], v[42:43], v[166:167]
    v_pk_add_f32 v[44:45], v[44:45], v[168:169]
    v_pk_add_f32 v[46:47], v[46:47], v[170:171]
    v_cvt_pk_bf16_f32 v140, v40, v41
    v_cvt_pk_bf16_f32 v141, v42, v43
    v_cvt_pk_bf16_f32 v142, v44, v45
    v_cvt_pk_bf16_f32 v143, v46, v47
    v_pk_fma_f32 v[164:165], v[48:49], v[112:113], s[64:65]
    v_pk_fma_f32 v[166:167], v[50:51], v[114:115], s[64:65]
    v_pk_fma_f32 v[168:169], v[52:53], v[116:117], s[64:65]
    v_pk_fma_f32 v[170:171], v[54:55], v[118:119], s[64:65]
    v_pk_mul_f32 v[48:49], v[48:49], v[120:121]
    v_pk_mul_f32 v[50:51], v[50:51], v[122:123]
    v_pk_mul_f32 v[52:53], v[52:53], v[124:125]
    v_pk_mul_f32 v[54:55], v[54:55], v[126:127]
    v_exp_f32_e64 v48, v48 clamp
    v_max_f32 v164, s64, v164
    v_exp_f32_e64 v49, v49 clamp
    v_max_f32 v165, s64, v165
    v_exp_f32_e64 v50, v50 clamp
    v_max_f32 v166, s64, v166
    v_exp_f32_e64 v51, v51 clamp
    v_max_f32 v167, s64, v167
    v_exp_f32_e64 v52, v52 clamp
    v_max_f32 v168, s64, v168
    v_exp_f32_e64 v53, v53 clamp
    v_max_f32 v169, s64, v169
    v_exp_f32_e64 v54, v54 clamp
    v_max_f32 v170, s64, v170
    v_exp_f32_e64 v55, v55 clamp
    v_max_f32 v171, s64, v171
    v_pk_add_f32 v[48:49], v[48:49], v[164:165]
    v_pk_add_f32 v[50:51], v[50:51], v[166:167]
    v_pk_add_f32 v[52:53], v[52:53], v[168:169]
    v_pk_add_f32 v[54:55], v[54:55], v[170:171]
    v_cvt_pk_bf16_f32 v144, v48, v49
    v_cvt_pk_bf16_f32 v145, v50, v51
    v_cvt_pk_bf16_f32 v146, v52, v53
    v_cvt_pk_bf16_f32 v147, v54, v55
    v_pk_fma_f32 v[164:165], v[56:57], v[112:113], s[64:65]
    v_pk_fma_f32 v[166:167], v[58:59], v[114:115], s[64:65]
    v_pk_fma_f32 v[168:169], v[60:61], v[116:117], s[64:65]
    v_pk_fma_f32 v[170:171], v[62:63], v[118:119], s[64:65]
    v_pk_mul_f32 v[56:57], v[56:57], v[120:121]
    v_pk_mul_f32 v[58:59], v[58:59], v[122:123]
    v_pk_mul_f32 v[60:61], v[60:61], v[124:125]
    v_pk_mul_f32 v[62:63], v[62:63], v[126:127]
    v_exp_f32_e64 v56, v56 clamp
    v_max_f32 v164, s64, v164
    v_exp_f32_e64 v57, v57 clamp
    v_max_f32 v165, s64, v165
    v_exp_f32_e64 v58, v58 clamp
    v_max_f32 v166, s64, v166
    v_exp_f32_e64 v59, v59 clamp
    v_max_f32 v167, s64, v167
    v_exp_f32_e64 v60, v60 clamp
    v_max_f32 v168, s64, v168
    v_exp_f32_e64 v61, v61 clamp
    v_max_f32 v169, s64, v169
    v_exp_f32_e64 v62, v62 clamp
    v_max_f32 v170, s64, v170
    v_exp_f32_e64 v63, v63 clamp
    v_max_f32 v171, s64, v171
    v_pk_add_f32 v[56:57], v[56:57], v[164:165]
    v_pk_add_f32 v[58:59], v[58:59], v[166:167]
    v_pk_add_f32 v[60:61], v[60:61], v[168:169]
    v_pk_add_f32 v[62:63], v[62:63], v[170:171]
    v_cvt_pk_bf16_f32 v148, v56, v57
    v_cvt_pk_bf16_f32 v149, v58, v59
    v_cvt_pk_bf16_f32 v150, v60, v61
    v_cvt_pk_bf16_f32 v151, v62, v63
    v_mfma_f32_16x16x32_bf16 v[40:43], v[140:143], v[152:155], 0
    v_mfma_f32_16x16x32_bf16 v[44:47], v[140:143], v[156:159], 0
    v_mfma_f32_16x16x32_bf16 v[52:55], v[144:147], v[152:155], 0
    v_mfma_f32_16x16x32_bf16 v[56:59], v[144:147], v[156:159], 0
    v_mfma_f32_16x16x32_bf16 v[60:63], v[144:147], v[160:163], 0
    v_mfma_f32_16x16x32_bf16 v[64:67], v[148:151], v[152:155], 0
    v_mfma_f32_16x16x32_bf16 v[68:71], v[148:151], v[156:159], 0
    v_mfma_f32_16x16x32_bf16 v[72:75], v[148:151], v[160:163], 0
    s_nop 0
    ds_write_b128 v16, v[40:43] offset:0
    ds_write_b128 v16, v[44:47] offset:1024
    ds_write_b128 v16, v[52:55] offset:3072
    ds_write_b128 v16, v[56:59] offset:4096
    ds_write_b128 v16, v[60:63] offset:5120
    ds_write_b128 v16, v[64:67] offset:6144
    ds_write_b128 v16, v[68:71] offset:7168
    ds_write_b128 v16, v[72:75] offset:8192
    s_waitcnt lgkmcnt(0)
    s_barrier
    ds_read_b128 v[64:67], v6 offset:0
    ds_read_b128 v[68:71], v6 offset:9216
    ds_read_b128 v[72:75], v6 offset:18432
    ds_read_b128 v[76:79], v6 offset:27648
    ds_read_b32 v104, v11 offset:0
    ds_read_b32 v108, v11 offset:128
    ds_read_b32 v106, v11 offset:64
    ds_read_b32 v110, v11 offset:192
    ds_read_b128 v[116:119], v13 offset:320
    ds_read_b128 v[120:123], v13 offset:384
    ds_read_b128 v[124:127], v13 offset:448
    s_waitcnt lgkmcnt(9)
    v_pk_add_f32 v[64:65], v[64:65], v[68:69]
    v_pk_add_f32 v[66:67], v[66:67], v[70:71]
    s_waitcnt lgkmcnt(8)
    v_pk_add_f32 v[64:65], v[64:65], v[72:73]
    v_pk_add_f32 v[66:67], v[66:67], v[74:75]
    s_waitcnt lgkmcnt(7)
    v_pk_add_f32 v[64:65], v[64:65], v[76:77]
    v_pk_add_f32 v[66:67], v[66:67], v[78:79]
    buffer_store_dwordx4 v[64:67], v17, s[4:7], s53 offen sc1
    v_mov_b32 v164, 0
    v_mov_b32 v165, 0
    v_mov_b32 v166, 0
    v_mov_b32 v167, 0
    ds_write_b128 v14, v[164:167]
    ds_write_b128 v14, v[164:167] offset:16
    s_waitcnt vmcnt(0) lgkmcnt(0)
    s_barrier
    s_cmp_lg_u32 s18, 0
    s_cbranch_scc1 L_noarr_45
    v_mov_b32 v19, 1
    s_mov_b64 exec, 2
    buffer_atomic_add v19, v5, s[4:7], 0 offen sc1
    s_mov_b64 exec, -1
L_noarr_45:
    s_cmp_lg_u32 s41, 0
    s_cbranch_scc1 L_l0_46
    s_cmp_lg_u32 s18, 0
    s_cbranch_scc1 L_nopoll_47
    s_mov_b64 exec, 12
    s_mov_b32 s47, 0
L_poll_48:
    buffer_load_dword v19, v5, s[4:7], 0 offen sc1
    s_add_u32 s47, s47, 1
    s_cmp_gt_u32 s47, 0x40000
    s_cbranch_scc1 L_pollout_49
    s_waitcnt vmcnt(0)
    v_cmp_gt_u32 vcc, s48, v19
    s_nop 0
    s_cbranch_vccnz L_poll_48
L_pollout_49:
    s_mov_b64 exec, -1
L_nopoll_47:
    s_barrier
L_l0_46:
    ds_read_b128 v[80:83], v1 offset:13312
    ds_read_b128 v[84:87], v1 offset:14336
    ds_read_b128 v[88:91], v1 offset:15360
    ds_read_b128 v[92:95], v1 offset:10240
    ds_read_b128 v[96:99], v1 offset:11264
    s_waitcnt lgkmcnt(4)
    v_mfma_f32_16x16x32_bf16 v[40:43], v[80:83], v[248:251], 0
    ds_read_b128 v[100:103], v1 offset:12288
    s_waitcnt lgkmcnt(4)
    v_mfma_f32_16x16x32_bf16 v[44:47], v[80:83], v[252:255], 0
    s_add_u32 s62, s63, 16384
    v_mfma_f32_16x16x32_bf16 v[48:51], v[84:87], v[248:251], 0
    ds_read_b128 v[80:83], v1 offset:7168
    s_waitcnt lgkmcnt(4)
    v_mfma_f32_16x16x32_bf16 v[52:55], v[84:87], v[252:255], 0
    buffer_load_dwordx4 a[68:71], v1, s[4:7], s62 offen offset:1024 sc1
    v_mfma_f32_16x16x32_bf16 v[56:59], v[88:91], v[248:251], 0
    ds_read_b128 v[84:87], v1 offset:8192
    s_waitcnt lgkmcnt(4)
    v_mfma_f32_16x16x32_bf16 v[60:63], v[88:91], v[252:255], 0
    buffer_load_dwordx4 a[72:75], v1, s[4:7], s62 offen offset:2048 sc1
    v_mfma_f32_16x16x32_bf16 v[40:43], v[92:95], v[240:243], v[40:43]
    ds_read_b128 v[88:91], v1 offset:9216
    s_waitcnt lgkmcnt(4)
    v_mfma_f32_16x16x32_bf16 v[44:47], v[92:95], v[244:247], v[44:47]
    v_mfma_f32_16x16x32_bf16 v[48:51], v[96:99], v[240:243], v[48:51]
    ds_read_b128 v[92:95], v1 offset:4096
    s_waitcnt lgkmcnt(4)
    v_mfma_f32_16x16x32_bf16 v[52:55], v[96:99], v[244:247], v[52:55]
    buffer_load_dwordx4 a[76:79], v1, s[4:7], s62 offen offset:3072 sc1
    v_mfma_f32_16x16x32_bf16 v[56:59], v[100:103], v[240:243], v[56:59]
    ds_read_b128 v[96:99], v1 offset:5120
    s_waitcnt lgkmcnt(4)
    v_mfma_f32_16x16x32_bf16 v[60:63], v[100:103], v[244:247], v[60:63]
    s_add_u32 s62, s63, 20480
    v_mfma_f32_16x16x32_bf16 v[40:43], v[80:83], v[232:235], v[40:43]
    ds_read_b128 v[100:103], v1 offset:6144
    s_waitcnt lgkmcnt(4)
    v_mfma_f32_16x16x32_bf16 v[44:47], v[80:83], v[236:239], v[44:47]
    buffer_load_dwordx4 a[80:83], v1, s[4:7], s62 offen offset:0 sc1
    v_mfma_f32_16x16x32_bf16 v[48:51], v[84:87], v[232:235], v[48:51]
    ds_read_b128 v[80:83], v1 offset:1024
    s_waitcnt lgkmcnt(4)
    v_mfma_f32_16x16x32_bf16 v[52:55], v[84:87], v[236:239], v[52:55]
    buffer_load_dwordx4 a[84:87], v1, s[4:7], s62 offen offset:1024 sc1
    v_mfma_f32_16x16x32_bf16 v[56:59], v[88:91], v[232:235], v[56:59]
    ds_read_b128 v[84:87], v1 offset:2048
    s_waitcnt lgkmcnt(4)
    v_mfma_f32_16x16x32_bf16 v[60:63], v[88:91], v[236:239], v[60:63]
    v_mfma_f32_16x16x32_bf16 v[40:43], v[92:95], v[224:227], v[40:43]
    ds_read_b128 v[88:91], v1 offset:3072
    s_waitcnt lgkmcnt(4)
    v_mfma_f32_16x16x32_bf16 v[44:47], v[92:95], v[228:231], v[44:47]
    buffer_load_dwordx4 a[88:91], v1, s[4:7], s62 offen offset:2048 sc1
    v_mfma_f32_16x16x32_bf16 v[48:51], v[96:99], v[224:227], v[48:51]
    ds_read_b128 v[92:95], v4 offset:14336
    s_waitcnt lgkmcnt(4)
    v_mfma_f32_16x16x32_bf16 v[52:55], v[96:99], v[228:231], v[52:55]
    buffer_load_dwordx4 a[92:95], v1, s[4:7], s62 offen offset:3072 sc1
    v_mfma_f32_16x16x32_bf16 v[56:59], v[100:103], v[224:227], v[56:59]
    ds_read_b128 v[96:99], v4 offset:15360
    s_waitcnt lgkmcnt(4)
    v_mfma_f32_16x16x32_bf16 v[60:63], v[100:103], v[228:231], v[60:63]
    s_add_u32 s62, s63, 24576
    v_mfma_f32_16x16x32_bf16 v[40:43], v[80:83], v[216:219], v[40:43]
    ds_read_b128 v[100:103], v1 offset:0
    s_waitcnt lgkmcnt(4)
    v_mfma_f32_16x16x32_bf16 v[44:47], v[80:83], v[220:223], v[44:47]
    buffer_load_dwordx4 a[96:99], v1, s[4:7], s62 offen offset:0 sc1
    v_mfma_f32_16x16x32_bf16 v[48:51], v[84:87], v[216:219], v[48:51]
    ds_read_b128 v[80:83], v4 offset:11264
    s_waitcnt lgkmcnt(4)
    v_mfma_f32_16x16x32_bf16 v[52:55], v[84:87], v[220:223], v[52:55]
    s_add_u32 s62, s70, 0
    v_mfma_f32_16x16x32_bf16 v[56:59], v[88:91], v[216:219], v[56:59]
    ds_read_b128 v[84:87], v4 offset:12288
    s_waitcnt lgkmcnt(4)
    v_mfma_f32_16x16x32_bf16 v[60:63], v[88:91], v[220:223], v[60:63]
    buffer_load_dwordx4 a[176:179], v1, s[4:7], s62 offen offset:0 sc1
    v_mfma_f32_16x16x32_bf16 v[40:43], v[92:95], v[208:211], v[40:43]
    ds_read_b128 v[88:91], v4 offset:13312
    s_waitcnt lgkmcnt(4)
    v_mfma_f32_16x16x32_bf16 v[44:47], v[92:95], v[212:215], v[44:47]
    buffer_load_dwordx4 a[180:183], v1, s[4:7], s62 offen offset:1024 sc1
    v_mfma_f32_16x16x32_bf16 v[48:51], v[96:99], v[208:211], v[48:51]
    ds_read_b128 v[92:95], v4 offset:8192
    s_waitcnt lgkmcnt(4)
    v_mfma_f32_16x16x32_bf16 v[52:55], v[96:99], v[212:215], v[52:55]
    v_mfma_f32_16x16x32_bf16 v[56:59], v[100:103], v[208:211], v[56:59]
    ds_read_b128 v[96:99], v4 offset:9216
    s_waitcnt lgkmcnt(4)
    v_mfma_f32_16x16x32_bf16 v[60:63], v[100:103], v[212:215], v[60:63]
    buffer_load_dwordx4 a[184:187], v1, s[4:7], s62 offen offset:2048 sc1
    v_mfma_f32_16x16x32_bf16 v[40:43], v[80:83], v[200:203], v[40:43]
    ds_read_b128 v[100:103], v4 offset:10240
    s_waitcnt lgkmcnt(4)
    v_mfma_f32_16x16x32_bf16 v[44:47], v[80:83], v[204:207], v[44:47]
    buffer_load_dwordx4 a[188:191], v1, s[4:7], s62 offen offset:3072 sc1
    v_mfma_f32_16x16x32_bf16 v[48:51], v[84:87], v[200:203], v[48:51]
    ds_read_b128 v[80:83], v4 offset:5120
    s_waitcnt lgkmcnt(4)
    v_mfma_f32_16x16x32_bf16 v[52:55], v[84:87], v[204:207], v[52:55]
    s_add_u32 s62, s70, 4096
    v_mfma_f32_16x16x32_bf16 v[56:59], v[88:91], v[200:203], v[56:59]
    ds_read_b128 v[84:87], v4 offset:6144
    s_waitcnt lgkmcnt(4)
    v_mfma_f32_16x16x32_bf16 v[60:63], v[88:91], v[204:207], v[60:63]
    buffer_load_dwordx4 a[192:195], v1, s[4:7], s62 offen offset:0 sc1
    v_mfma_f32_16x16x32_bf16 v[40:43], v[92:95], v[192:195], v[40:43]
    ds_read_b128 v[88:91], v4 offset:7168
    s_waitcnt lgkmcnt(4)
    v_mfma_f32_16x16x32_bf16 v[44:47], v[92:95], v[196:199], v[44:47]
    buffer_load_dwordx4 a[196:199], v1, s[4:7], s62 offen offset:1024 sc1
    v_mfma_f32_16x16x32_bf16 v[48:51], v[96:99], v[192:195], v[48:51]
    ds_read_b128 v[92:95], v4 offset:2048
    s_waitcnt lgkmcnt(4)
    v_mfma_f32_16x16x32_bf16 v[52:55], v[96:99], v[196:199], v[52:55]
    v_mfma_f32_16x16x32_bf16 v[56:59], v[100:103], v[192:195], v[56:59]
    ds_read_b128 v[96:99], v4 offset:3072
    s_waitcnt lgkmcnt(4)
    v_mfma_f32_16x16x32_bf16 v[60:63], v[100:103], v[196:199], v[60:63]
    buffer_load_dwordx4 a[200:203], v1, s[4:7], s62 offen offset:2048 sc1
    v_mfma_f32_16x16x32_bf16 v[40:43], v[80:83], v[184:187], v[40:43]
    ds_read_b128 v[100:103], v4 offset:4096
    s_waitcnt lgkmcnt(4)
    v_mfma_f32_16x16x32_bf16 v[44:47], v[80:83], v[188:191], v[44:47]
    buffer_load_dwordx4 a[204:207], v1, s[4:7], s62 offen offset:3072 sc1
    v_mfma_f32_16x16x32_bf16 v[48:51], v[84:87], v[184:187], v[48:51]
    ds_read_b128 v[80:83], v3 offset:64512
    s_waitcnt lgkmcnt(4)
    v_mfma_f32_16x16x32_bf16 v[52:55], v[84:87], v[188:191], v[52:55]
    s_add_u32 s62, s70, 8192
    v_mfma_f32_16x16x32_bf16 v[56:59], v[88:91], v[184:187], v[56:59]
    ds_read_b128 v[84:87], v4 offset:0
    s_waitcnt lgkmcnt(4)
    v_mfma_f32_16x16x32_bf16 v[60:63], v[88:91], v[188:191], v[60:63]
    buffer_load_dwordx4 a[208:211], v1, s[4:7], s62 offen offset:0 sc1
    v_mfma_f32_16x16x32_bf16 v[40:43], v[92:95], v[176:179], v[40:43]
    ds_read_b128 v[88:91], v4 offset:1024
    s_waitcnt lgkmcnt(4)
    v_mfma_f32_16x16x32_bf16 v[44:47], v[92:95], v[180:183], v[44:47]
    buffer_load_dwordx4 a[212:215], v1, s[4:7], s62 offen offset:1024 sc1
    v_mfma_f32_16x16x32_bf16 v[48:51], v[96:99], v[176:179], v[48:51]
    ds_read_b128 v[92:95], v3 offset:61440
    s_waitcnt lgkmcnt(4)
    v_mfma_f32_16x16x32_bf16 v[52:55], v[96:99], v[180:183], v[52:55]
    v_mfma_f32_16x16x32_bf16 v[56:59], v[100:103], v[176:179], v[56:59]
    ds_read_b128 v[96:99], v3 offset:62464
    s_waitcnt lgkmcnt(4)
    v_mfma_f32_16x16x32_bf16 v[60:63], v[100:103], v[180:183], v[60:63]
    buffer_load_dwordx4 a[216:219], v1, s[4:7], s62 offen offset:2048 sc1
    v_mfma_f32_16x16x32_bf16 v[40:43], v[80:83], a[172:175], v[40:43]
    ds_read_b128 v[100:103], v3 offset:63488
    s_waitcnt lgkmcnt(4)
    v_mfma_f32_16x16x32_bf16 v[44:47], v[80:83], v[172:175], v[44:47]
    buffer_load_dwordx4 a[220:223], v1, s[4:7], s62 offen offset:3072 sc1
    v_mfma_f32_16x16x32_bf16 v[48:51], v[84:87], a[172:175], v[48:51]
    ds_read_b128 v[80:83], v3 offset:58368
    s_waitcnt lgkmcnt(4)
    v_mfma_f32_16x16x32_bf16 v[52:55], v[84:87], v[172:175], v[52:55]
    s_cmp_lg_u32 s41, 0
    s_cbranch_scc1 L_l0_50
    s_add_u32 s62, s63, 0
    buffer_load_dwordx4 a[0:3], v1, s[4:7], s62 offen offset:0 sc1
    buffer_load_dwordx4 a[4:7], v1, s[4:7], s62 offen offset:1024 sc1
    buffer_load_dwordx4 a[8:11], v1, s[4:7], s62 offen offset:2048 sc1
    buffer_load_dwordx4 a[12:15], v1, s[4:7], s62 offen offset:3072 sc1
    s_add_u32 s62, s63, 4096
    buffer_load_dwordx4 a[16:19], v1, s[4:7], s62 offen offset:0 sc1
    buffer_load_dwordx4 a[20:23], v1, s[4:7], s62 offen offset:1024 sc1
    buffer_load_dwordx4 a[24:27], v1, s[4:7], s62 offen offset:2048 sc1
    buffer_load_dwordx4 a[28:31], v1, s[4:7], s62 offen offset:3072 sc1
    s_add_u32 s62, s63, 8192
    buffer_load_dwordx4 a[32:35], v1, s[4:7], s62 offen offset:0 sc1
    buffer_load_dwordx4 a[36:39], v1, s[4:7], s62 offen offset:1024 sc1
    buffer_load_dwordx4 a[40:43], v1, s[4:7], s62 offen offset:2048 sc1
    buffer_load_dwordx4 a[44:47], v1, s[4:7], s62 offen offset:3072 sc1
    s_add_u32 s62, s63, 12288
    buffer_load_dwordx4 a[48:51], v1, s[4:7], s62 offen offset:0 sc1
    buffer_load_dwordx4 a[52:55], v1, s[4:7], s62 offen offset:1024 sc1
    buffer_load_dwordx4 a[56:59], v1, s[4:7], s62 offen offset:2048 sc1
    buffer_load_dwordx4 a[60:63], v1, s[4:7], s62 offen offset:3072 sc1
    s_add_u32 s62, s63, 16384
    buffer_load_dwordx4 a[64:67], v1, s[4:7], s62 offen offset:0 sc1
L_l0_50:
    v_mfma_f32_16x16x32_bf16 v[56:59], v[88:91], a[172:175], v[56:59]
    ds_read_b128 v[84:87], v3 offset:59392
    s_waitcnt lgkmcnt(4)
    v_mfma_f32_16x16x32_bf16 v[60:63], v[88:91], v[172:175], v[60:63]
    s_cmp_lg_u32 s41, 0
    s_cbranch_scc1 L_l0_51
    s_mul_i32 s100, s17, 20480
    s_add_u32 s100, s100, 294912
    v_lshrrev_b32 v64, 2, v9
    v_lshrrev_b32 v144, 9, v64
    v_mul_u32_u24 v144, 9728, v144
    v_add_u32 v64, v64, v144
    buffer_load_dword v144, v64, s[4:7], s100 offen offset:0 sc1
    buffer_load_dword v145, v64, s[4:7], s100 offen offset:512 sc1
    buffer_load_dword v146, v64, s[4:7], s100 offen offset:1024 sc1
    buffer_load_dword v147, v64, s[4:7], s100 offen offset:1536 sc1
    buffer_load_dword v148, v64, s[4:7], s100 offen offset:2048 sc1
    buffer_load_dword v149, v64, s[4:7], s100 offen offset:2560 sc1
    buffer_load_dword v150, v64, s[4:7], s100 offen offset:3072 sc1
    buffer_load_dword v151, v64, s[4:7], s100 offen offset:3584 sc1
    s_add_u32 s100, s100, 4096
    buffer_load_dword v152, v64, s[4:7], s100 offen offset:0 sc1
    buffer_load_dword v153, v64, s[4:7], s100 offen offset:512 sc1
    buffer_load_dword v154, v64, s[4:7], s100 offen offset:1024 sc1
    buffer_load_dword v155, v64, s[4:7], s100 offen offset:1536 sc1
    buffer_load_dword v156, v64, s[4:7], s100 offen offset:2048 sc1
    buffer_load_dword v157, v64, s[4:7], s100 offen offset:2560 sc1
    buffer_load_dword v158, v64, s[4:7], s100 offen offset:3072 sc1
    buffer_load_dword v159, v64, s[4:7], s100 offen offset:3584 sc1
    s_add_u32 s100, s100, 4096
    buffer_load_dword v160, v64, s[4:7], s100 offen offset:0 sc1
    buffer_load_dword v161, v64, s[4:7], s100 offen offset:512 sc1
    buffer_load_dword v162, v64, s[4:7], s100 offen offset:1024 sc1
    buffer_load_dword v163, v64, s[4:7], s100 offen offset:1536 sc1
L_l0_51:
    v_mfma_f32_16x16x32_bf16 v[40:43], v[92:95], a[164:167], v[40:43]
    ds_read_b128 v[88:91], v3 offset:60416
    s_waitcnt lgkmcnt(4)
    v_mfma_f32_16x16x32_bf16 v[44:47], v[92:95], a[168:171], v[44:47]
    v_mfma_f32_16x16x32_bf16 v[48:51], v[96:99], a[164:167], v[48:51]
    ds_read_b128 v[92:95], v3 offset:55296
    s_waitcnt lgkmcnt(4)
    v_mfma_f32_16x16x32_bf16 v[52:55], v[96:99], a[168:171], v[52:55]
    v_mfma_f32_16x16x32_bf16 v[56:59], v[100:103], a[164:167], v[56:59]
    ds_read_b128 v[96:99], v3 offset:56320
    s_waitcnt lgkmcnt(4)
    v_mfma_f32_16x16x32_bf16 v[60:63], v[100:103], a[168:171], v[60:63]
    v_mfma_f32_16x16x32_bf16 v[40:43], v[80:83], a[156:159], v[40:43]
    ds_read_b128 v[100:103], v3 offset:57344
    s_waitcnt lgkmcnt(4)
    v_mfma_f32_16x16x32_bf16 v[44:47], v[80:83], a[160:163], v[44:47]
    s_cmp_lg_u32 s18, 0
    s_cbranch_scc1 L_nopoll_52
    s_mov_b64 exec, 2
    s_mov_b32 s47, 0
L_poll_53:
    buffer_load_dword v19, v5, s[4:7], 0 offen sc1
    s_add_u32 s47, s47, 1
    s_cmp_gt_u32 s47, 0x40000
    s_cbranch_scc1 L_pollout_54
    s_waitcnt vmcnt(0)
    v_cmp_gt_u32 vcc, s46, v19
    s_nop 0
    s_cbranch_vccnz L_poll_53
L_pollout_54:
    s_mov_b64 exec, -1
L_nopoll_52:
    s_barrier
    buffer_load_dwordx4 v[176:179], v17, s[4:7], s52 offen sc1
    s_add_u32 s52, s52, 4096
    buffer_load_dwordx4 v[180:183], v17, s[4:7], s52 offen sc1
    s_add_u32 s52, s52, 4096
    buffer_load_dwordx4 v[184:187], v17, s[4:7], s52 offen sc1
    s_add_u32 s52, s52, 4096
    buffer_load_dwordx4 v[188:191], v17, s[4:7], s52 offen sc1
    s_add_u32 s52, s52, 4096
    buffer_load_dwordx4 v[192:195], v17, s[4:7], s52 offen sc1
    s_add_u32 s52, s52, 4096
    buffer_load_dwordx4 v[196:199], v17, s[4:7], s52 offen sc1
    s_add_u32 s52, s52, 4096
    buffer_load_dwordx4 v[200:203], v17, s[4:7], s52 offen sc1
    s_add_u32 s52, s52, 4096
    buffer_load_dwordx4 v[204:207], v17, s[4:7], s52 offen sc1
    s_add_u32 s52, s52, 4096
    buffer_load_dwordx4 v[208:211], v17, s[4:7], s52 offen sc1
    s_add_u32 s52, s52, 4096
    buffer_load_dwordx4 v[212:215], v17, s[4:7], s52 offen sc1
    s_add_u32 s52, s52, 4096
    buffer_load_dwordx4 v[216:219], v17, s[4:7], s52 offen sc1
    s_add_u32 s52, s52, 4096
    buffer_load_dwordx4 v[220:223], v17, s[4:7], s52 offen sc1
    s_add_u32 s52, s52, 4096
    buffer_load_dwordx4 v[224:227], v17, s[4:7], s52 offen sc1
    s_add_u32 s52, s52, 4096
    buffer_load_dwordx4 v[228:231], v17, s[4:7], s52 offen sc1
    s_add_u32 s52, s52, 4096
    buffer_load_dwordx4 v[232:235], v17, s[4:7], s52 offen sc1
    s_add_u32 s52, s52, 4096
    buffer_load_dwordx4 v[236:239], v17, s[4:7], s52 offen sc1
    v_mfma_f32_16x16x32_bf16 v[48:51], v[84:87], a[156:159], v[48:51]
    ds_read_b128 v[80:83], v3 offset:52224
    s_waitcnt lgkmcnt(4)
    v_mfma_f32_16x16x32_bf16 v[52:55], v[84:87], a[160:163], v[52:55]
    v_mfma_f32_16x16x32_bf16 v[56:59], v[88:91], a[156:159], v[56:59]
    ds_read_b128 v[84:87], v3 offset:53248
    s_waitcnt lgkmcnt(4)
    v_mfma_f32_16x16x32_bf16 v[60:63], v[88:91], a[160:163], v[60:63]
    v_mfma_f32_16x16x32_bf16 v[40:43], v[92:95], a[148:151], v[40:43]
    ds_read_b128 v[88:91], v3 offset:54272
    s_waitcnt lgkmcnt(4)
    v_mfma_f32_16x16x32_bf16 v[44:47], v[92:95], a[152:155], v[44:47]
    v_mfma_f32_16x16x32_bf16 v[48:51], v[96:99], a[148:151], v[48:51]
    ds_read_b128 v[92:95], v3 offset:49152
    s_waitcnt lgkmcnt(4)
    v_mfma_f32_16x16x32_bf16 v[52:55], v[96:99], a[152:155], v[52:55]
    v_mfma_f32_16x16x32_bf16 v[56:59], v[100:103], a[148:151], v[56:59]
    ds_read_b128 v[96:99], v3 offset:50176
    s_waitcnt lgkmcnt(4)
    v_mfma_f32_16x16x32_bf16 v[60:63], v[100:103], a[152:155], v[60:63]
    v_mfma_f32_16x16x32_bf16 v[40:43], v[80:83], a[140:143], v[40:43]
    ds_read_b128 v[100:103], v3 offset:51200
    s_waitcnt lgkmcnt(4)
    v_mfma_f32_16x16x32_bf16 v[44:47], v[80:83], a[144:147], v[44:47]
    v_mfma_f32_16x16x32_bf16 v[48:51], v[84:87], a[140:143], v[48:51]
    ds_read_b128 v[80:83], v3 offset:46080
    s_waitcnt lgkmcnt(4)
    v_mfma_f32_16x16x32_bf16 v[52:55], v[84:87], a[144:147], v[52:55]
    v_mfma_f32_16x16x32_bf16 v[56:59], v[88:91], a[140:143], v[56:59]
    ds_read_b128 v[84:87], v3 offset:47104
    s_waitcnt lgkmcnt(4)
    v_mfma_f32_16x16x32_bf16 v[60:63], v[88:91], a[144:147], v[60:63]
    v_mfma_f32_16x16x32_bf16 v[40:43], v[92:95], a[132:135], v[40:43]
    ds_read_b128 v[88:91], v3 offset:48128
    s_waitcnt lgkmcnt(4)
    v_mfma_f32_16x16x32_bf16 v[44:47], v[92:95], a[136:139], v[44:47]
    v_mfma_f32_16x16x32_bf16 v[48:51], v[96:99], a[132:135], v[48:51]
    ds_read_b128 v[92:95], v3 offset:43008
    s_waitcnt lgkmcnt(4)
    v_mfma_f32_16x16x32_bf16 v[52:55], v[96:99], a[136:139], v[52:55]
    v_mfma_f32_16x16x32_bf16 v[56:59], v[100:103], a[132:135], v[56:59]
    ds_read_b128 v[96:99], v3 offset:44032
    s_waitcnt lgkmcnt(4)
    v_mfma_f32_16x16x32_bf16 v[60:63], v[100:103], a[136:139], v[60:63]
    v_mfma_f32_16x16x32_bf16 v[40:43], v[80:83], a[124:127], v[40:43]
    ds_read_b128 v[100:103], v3 offset:45056
    s_waitcnt lgkmcnt(4)
    v_mfma_f32_16x16x32_bf16 v[44:47], v[80:83], a[128:131], v[44:47]
    v_mfma_f32_16x16x32_bf16 v[48:51], v[84:87], a[124:127], v[48:51]
    ds_read_b128 v[80:83], v3 offset:39936
    s_waitcnt lgkmcnt(4)
    v_mfma_f32_16x16x32_bf16 v[52:55], v[84:87], a[128:131], v[52:55]
    v_mfma_f32_16x16x32_bf16 v[56:59], v[88:91], a[124:127], v[56:59]
    ds_read_b128 v[84:87], v3 offset:40960
    s_waitcnt lgkmcnt(4)
    v_mfma_f32_16x16x32_bf16 v[60:63], v[88:91], a[128:131], v[60:63]
    v_mfma_f32_16x16x32_bf16 v[40:43], v[92:95], a[116:119], v[40:43]
    ds_read_b128 v[88:91], v3 offset:41984
    s_waitcnt lgkmcnt(4)
    v_mfma_f32_16x16x32_bf16 v[44:47], v[92:95], a[120:123], v[44:47]
    v_mfma_f32_16x16x32_bf16 v[48:51], v[96:99], a[116:119], v[48:51]
    ds_read_b128 v[92:95], v3 offset:36864
    s_waitcnt lgkmcnt(4)
    v_mfma_f32_16x16x32_bf16 v[52:55], v[96:99], a[120:123], v[52:55]
    v_mfma_f32_16x16x32_bf16 v[56:59], v[100:103], a[116:119], v[56:59]
    ds_read_b128 v[96:99], v3 offset:37888
    s_waitcnt lgkmcnt(4)
    v_mfma_f32_16x16x32_bf16 v[60:63], v[100:103], a[120:123], v[60:63]
    v_mfma_f32_16x16x32_bf16 v[40:43], v[80:83], a[108:111], v[40:43]
    ds_read_b128 v[100:103], v3 offset:38912
    s_waitcnt lgkmcnt(4)
    v_mfma_f32_16x16x32_bf16 v[44:47], v[80:83], a[112:115], v[44:47]
    v_mfma_f32_16x16x32_bf16 v[48:51], v[84:87], a[108:111], v[48:51]
    s_waitcnt lgkmcnt(3)
    v_mfma_f32_16x16x32_bf16 v[52:55], v[84:87], a[112:115], v[52:55]
    v_mfma_f32_16x16x32_bf16 v[56:59], v[88:91], a[108:111], v[56:59]
    s_waitcnt lgkmcnt(2)
    v_mfma_f32_16x16x32_bf16 v[60:63], v[88:91], a[112:115], v[60:63]
    v_mfma_f32_16x16x32_bf16 v[40:43], v[92:95], a[100:103], v[40:43]
    s_waitcnt lgkmcnt(1)
    v_mfma_f32_16x16x32_bf16 v[44:47], v[92:95], a[104:107], v[44:47]
    v_mfma_f32_16x16x32_bf16 v[48:51], v[96:99], a[100:103], v[48:51]
    s_waitcnt lgkmcnt(0)
    v_mfma_f32_16x16x32_bf16 v[52:55], v[96:99], a[104:107], v[52:55]
    v_mfma_f32_16x16x32_bf16 v[56:59], v[100:103], a[100:103], v[56:59]
    v_mfma_f32_16x16x32_bf16 v[60:63], v[100:103], a[104:107], v[60:63]
    v_mul_f32 v112, 0x3fb8aa3b, v108
    v_mov_b32 v134, 0
    v_mov_b32 v135, 0
    v_mul_f32 v114, 0x3fb8aa3b, v110
    v_mov_b32 v142, 0
    v_mov_b32 v143, 0
    v_pk_fma_f32 v[40:41], v[116:117], v[104:105], v[40:41] op_sel_hi:[1,0,1]
    v_pk_fma_f32 v[42:43], v[118:119], v[104:105], v[42:43] op_sel_hi:[1,0,1]
    v_pk_fma_f32 v[44:45], v[116:117], v[106:107], v[44:45] op_sel_hi:[1,0,1]
    v_pk_fma_f32 v[46:47], v[118:119], v[106:107], v[46:47] op_sel_hi:[1,0,1]
    v_pk_fma_f32 v[48:49], v[120:121], v[104:105], v[48:49] op_sel_hi:[1,0,1]
    v_pk_fma_f32 v[50:51], v[122:123], v[104:105], v[50:51] op_sel_hi:[1,0,1]
    v_pk_fma_f32 v[52:53], v[120:121], v[106:107], v[52:53] op_sel_hi:[1,0,1]
    v_pk_fma_f32 v[54:55], v[122:123], v[106:107], v[54:55] op_sel_hi:[1,0,1]
    v_pk_fma_f32 v[56:57], v[124:125], v[104:105], v[56:57] op_sel_hi:[1,0,1]
    v_pk_fma_f32 v[58:59], v[126:127], v[104:105], v[58:59] op_sel_hi:[1,0,1]
    v_pk_fma_f32 v[60:61], v[124:125], v[106:107], v[60:61] op_sel_hi:[1,0,1]
    v_pk_fma_f32 v[62:63], v[126:127], v[106:107], v[62:63] op_sel_hi:[1,0,1]
    v_pk_fma_f32 v[164:165], v[40:41], v[108:109], s[64:65] op_sel_hi:[1,0,1]
    v_pk_fma_f32 v[166:167], v[42:43], v[108:109], s[64:65] op_sel_hi:[1,0,1]
    v_pk_fma_f32 v[168:169], v[44:45], v[110:111], s[64:65] op_sel_hi:[1,0,1]
    v_pk_fma_f32 v[170:171], v[46:47], v[110:111], s[64:65] op_sel_hi:[1,0,1]
    v_pk_mul_f32 v[40:41], v[40:41], v[112:113] op_sel_hi:[1,0]
    v_pk_mul_f32 v[42:43], v[42:43], v[112:113] op_sel_hi:[1,0]
    v_pk_mul_f32 v[44:45], v[44:45], v[114:115] op_sel_hi:[1,0]
    v_pk_mul_f32 v[46:47], v[46:47], v[114:115] op_sel_hi:[1,0]
    v_exp_f32_e64 v40, v40 clamp
    v_max_f32 v164, s64, v164
    v_exp_f32_e64 v41, v41 clamp
    v_max_f32 v165, s64, v165
    v_exp_f32_e64 v42, v42 clamp
    v_max_f32 v166, s64, v166
    v_exp_f32_e64 v43, v43 clamp
    v_max_f32 v167, s64, v167
    v_exp_f32_e64 v44, v44 clamp
    v_max_f32 v168, s64, v168
    v_exp_f32_e64 v45, v45 clamp
    v_max_f32 v169, s64, v169
    v_exp_f32_e64 v46, v46 clamp
    v_max_f32 v170, s64, v170
    v_exp_f32_e64 v47, v47 clamp
    v_max_f32 v171, s64, v171
    v_pk_add_f32 v[40:41], v[40:41], v[164:165]
    v_pk_add_f32 v[42:43], v[42:43], v[166:167]
    v_pk_add_f32 v[44:45], v[44:45], v[168:169]
    v_pk_add_f32 v[46:47], v[46:47], v[170:171]
    v_cvt_pk_bf16_f32 v128, v40, v41
    v_cvt_pk_bf16_f32 v129, v42, v43
    v_cvt_pk_bf16_f32 v136, v44, v45
    v_cvt_pk_bf16_f32 v137, v46, v47
    v_pk_fma_f32 v[164:165], v[48:49], v[108:109], s[64:65] op_sel_hi:[1,0,1]
    v_pk_fma_f32 v[166:167], v[50:51], v[108:109], s[64:65] op_sel_hi:[1,0,1]
    v_pk_fma_f32 v[168:169], v[52:53], v[110:111], s[64:65] op_sel_hi:[1,0,1]
    v_pk_fma_f32 v[170:171], v[54:55], v[110:111], s[64:65] op_sel_hi:[1,0,1]
    v_pk_mul_f32 v[48:49], v[48:49], v[112:113] op_sel_hi:[1,0]
    v_pk_mul_f32 v[50:51], v[50:51], v[112:113] op_sel_hi:[1,0]
    v_pk_mul_f32 v[52:53], v[52:53], v[114:115] op_sel_hi:[1,0]
    v_pk_mul_f32 v[54:55], v[54:55], v[114:115] op_sel_hi:[1,0]
    v_exp_f32_e64 v48, v48 clamp
    v_max_f32 v164, s64, v164
    v_exp_f32_e64 v49, v49 clamp
    v_max_f32 v165, s64, v165
    v_exp_f32_e64 v50, v50 clamp
    v_max_f32 v166, s64, v166
    v_exp_f32_e64 v51, v51 clamp
    v_max_f32 v167, s64, v167
    v_exp_f32_e64 v52, v52 clamp
    v_max_f32 v168, s64, v168
    v_exp_f32_e64 v53, v53 clamp
    v_max_f32 v169, s64, v169
    v_exp_f32_e64 v54, v54 clamp
    v_max_f32 v170, s64, v170
    v_exp_f32_e64 v55, v55 clamp
    v_max_f32 v171, s64, v171
    v_pk_add_f32 v[48:49], v[48:49], v[164:165]
    v_pk_add_f32 v[50:51], v[50:51], v[166:167]
    v_pk_add_f32 v[52:53], v[52:53], v[168:169]
    v_pk_add_f32 v[54:55], v[54:55], v[170:171]
    v_cvt_pk_bf16_f32 v130, v48, v49
    v_cvt_pk_bf16_f32 v131, v50, v51
    v_cvt_pk_bf16_f32 v138, v52, v53
    v_cvt_pk_bf16_f32 v139, v54, v55
    v_pk_fma_f32 v[164:165], v[56:57], v[108:109], s[64:65] op_sel_hi:[1,0,1]
    v_pk_fma_f32 v[166:167], v[58:59], v[108:109], s[64:65] op_sel_hi:[1,0,1]
    v_pk_fma_f32 v[168:169], v[60:61], v[110:111], s[64:65] op_sel_hi:[1,0,1]
    v_pk_fma_f32 v[170:171], v[62:63], v[110:111], s[64:65] op_sel_hi:[1,0,1]
    v_pk_mul_f32 v[56:57], v[56:57], v[112:113] op_sel_hi:[1,0]
    v_pk_mul_f32 v[58:59], v[58:59], v[112:113] op_sel_hi:[1,0]
    v_pk_mul_f32 v[60:61], v[60:61], v[114:115] op_sel_hi:[1,0]
    v_pk_mul_f32 v[62:63], v[62:63], v[114:115] op_sel_hi:[1,0]
    v_exp_f32_e64 v56, v56 clamp
    v_max_f32 v164, s64, v164
    v_exp_f32_e64 v57, v57 clamp
    v_max_f32 v165, s64, v165
    v_exp_f32_e64 v58, v58 clamp
    v_max_f32 v166, s64, v166
    v_exp_f32_e64 v59, v59 clamp
    v_max_f32 v167, s64, v167
    v_exp_f32_e64 v60, v60 clamp
    v_max_f32 v168, s64, v168
    v_exp_f32_e64 v61, v61 clamp
    v_max_f32 v169, s64, v169
    v_exp_f32_e64 v62, v62 clamp
    v_max_f32 v170, s64, v170
    v_exp_f32_e64 v63, v63 clamp
    v_max_f32 v171, s64, v171
    v_pk_add_f32 v[56:57], v[56:57], v[164:165]
    v_pk_add_f32 v[58:59], v[58:59], v[166:167]
    v_pk_add_f32 v[60:61], v[60:61], v[168:169]
    v_pk_add_f32 v[62:63], v[62:63], v[170:171]
    v_cvt_pk_bf16_f32 v132, v56, v57
    v_cvt_pk_bf16_f32 v133, v58, v59
    v_cvt_pk_bf16_f32 v140, v60, v61
    v_cvt_pk_bf16_f32 v141, v62, v63
    s_mul_i32 s52, s41, 2621440
    s_mul_i32 s3, s72, 20480
    s_add_u32 s52, s52, s3
    s_add_u32 s52, s52, 23977984
    s_lshl_b32 s3, s17, 10
    s_add_u32 s96, s52, s3
    s_add_u32 s97, s96, 20480
    s_lshr_b32 s3, s17, 2
    s_lshl_b32 s3, s3, 10
    s_add_u32 s52, s52, s3
    s_and_b32 s3, s17, 3
    s_lshl_b32 s3, s3, 8
    s_add_u32 s52, s52, s3
    s_add_u32 s98, s52, 16384
    v_and_b32 v14, 15, v0
    v_lshlrev_b32 v14, 4, v14
    v_bfe_u32 v11, v0, 4, 1
    v_mul_u32_u24 v11, 20480, v11
    v_add_u32 v14, v14, v11
    s_cmp_lg_u32 s41, 0
    s_cbranch_scc1 L_l0_55
    s_waitcnt vmcnt(16)
    v_add_f32 v144, v144, v145
    v_add_f32 v144, v144, v146
    v_add_f32 v144, v144, v147
    v_add_f32 v144, v144, v148
    v_add_f32 v144, v144, v149
    v_add_f32 v144, v144, v150
    v_add_f32 v144, v144, v151
    v_add_f32 v144, v144, v152
    v_add_f32 v144, v144, v153
    v_add_f32 v144, v144, v154
    v_add_f32 v144, v144, v155
    v_add_f32 v144, v144, v156
    v_add_f32 v144, v144, v157
    v_add_f32 v144, v144, v158
    v_add_f32 v144, v144, v159
    v_add_f32 v144, v144, v160
    v_add_f32 v144, v144, v161
    v_add_f32 v144, v144, v162
    v_add_f32 v144, v144, v163
    v_lshrrev_b32 v64, 2, v9
    v_add_u32 v64, 161280, v64
    ds_write_b32 v64, v144
    s_waitcnt lgkmcnt(0)
L_l0_55:
    s_add_u32 s46, s46, 16
    s_waitcnt vmcnt(11)
    v_pk_add_f32 v[176:177], v[176:177], v[180:181]
    v_pk_add_f32 v[178:179], v[178:179], v[182:183]
    v_pk_add_f32 v[176:177], v[176:177], v[184:185]
    v_pk_add_f32 v[178:179], v[178:179], v[186:187]
    v_pk_add_f32 v[176:177], v[176:177], v[188:189]
    v_pk_add_f32 v[178:179], v[178:179], v[190:191]
    v_pk_add_f32 v[176:177], v[176:177], v[192:193]
    v_pk_add_f32 v[178:179], v[178:179], v[194:195]
    s_waitcnt vmcnt(7)
    v_pk_add_f32 v[176:177], v[176:177], v[196:197]
    v_pk_add_f32 v[178:179], v[178:179], v[198:199]
    v_pk_add_f32 v[176:177], v[176:177], v[200:201]
    v_pk_add_f32 v[178:179], v[178:179], v[202:203]
    v_pk_add_f32 v[176:177], v[176:177], v[204:205]
    v_pk_add_f32 v[178:179], v[178:179], v[206:207]
    v_pk_add_f32 v[176:177], v[176:177], v[208:209]
    v_pk_add_f32 v[178:179], v[178:179], v[210:211]
    s_waitcnt vmcnt(3)
    v_pk_add_f32 v[176:177], v[176:177], v[212:213]
    v_pk_add_f32 v[178:179], v[178:179], v[214:215]
    v_pk_add_f32 v[176:177], v[176:177], v[216:217]
    v_pk_add_f32 v[178:179], v[178:179], v[218:219]
    v_pk_add_f32 v[176:177], v[176:177], v[220:221]
    v_pk_add_f32 v[178:179], v[178:179], v[222:223]
    v_pk_add_f32 v[176:177], v[176:177], v[224:225]
    v_pk_add_f32 v[178:179], v[178:179], v[226:227]
    s_waitcnt vmcnt(0)
    v_pk_add_f32 v[176:177], v[176:177], v[228:229]
    v_pk_add_f32 v[178:179], v[178:179], v[230:231]
    v_pk_add_f32 v[176:177], v[176:177], v[232:233]
    v_pk_add_f32 v[178:179], v[178:179], v[234:235]
    v_pk_add_f32 v[176:177], v[176:177], v[236:237]
    v_pk_add_f32 v[178:179], v[178:179], v[238:239]
    v_cvt_pk_bf16_f32 v44, v176, v177
    v_cvt_pk_bf16_f32 v45, v178, v179
    ds_write_b64 v7, v[44:45]
    s_add_u32 m0, s42, 0
    s_add_u32 s43, s95, 0
    buffer_load_dwordx4 v2, s[4:7], s43 offen sc1 lds
    buffer_load_dwordx4 v2, s[4:7], s43 offen offset:1024 sc1 lds
    s_add_u32 m0, s42, 8192
    s_add_u32 s43, s95, 8192
    buffer_load_dwordx4 v2, s[4:7], s43 offen sc1 lds
    buffer_load_dwordx4 v2, s[4:7], s43 offen offset:1024 sc1 lds
    s_add_u32 m0, s42, 65536
    s_add_u32 s43, s95, 65536
    buffer_load_dwordx4 v2, s[4:7], s43 offen sc1 lds
    buffer_load_dwordx4 v2, s[4:7], s43 offen offset:1024 sc1 lds
    s_add_u32 m0, s42, 73728
    s_add_u32 s43, s95, 73728
    buffer_load_dwordx4 v2, s[4:7], s43 offen sc1 lds
    buffer_load_dwordx4 v2, s[4:7], s43 offen offset:1024 sc1 lds
    s_add_u32 m0, s42, 81920
    s_add_u32 s43, s95, 81920
    buffer_load_dwordx4 v2, s[4:7], s43 offen sc1 lds
    buffer_load_dwordx4 v2, s[4:7], s43 offen offset:1024 sc1 lds
    s_cmp_lg_u32 s18, 3
    s_cbranch_scc1 L_noz_56
    s_mov_b64 exec, 0x3ff00
    ds_write_b64 v7, v[44:45] offset:32
    ds_write_b64 v7, v[44:45] offset:64
    ds_write_b64 v7, v[44:45] offset:96
    ds_write_b64 v7, v[44:45] offset:128
    ds_write_b64 v7, v[44:45] offset:160
    ds_write_b64 v7, v[44:45] offset:192
    ds_write_b64 v7, v[44:45] offset:224
    s_mov_b64 exec, -1
L_noz_56:
    s_waitcnt lgkmcnt(0)
    s_barrier
    ds_read_b128 v[48:51], v1 offset:53248
    ds_read_b128 v[52:55], v1 offset:55296
    ds_read_b128 v[56:59], v1 offset:56320
    ds_read_b128 v[60:63], v1 offset:57344
    ds_read_b128 v[64:67], v1 offset:58368
    ds_read_b128 v[68:71], v1 offset:59392
    ds_read_b128 v[72:75], v1 offset:60416
    s_waitcnt lgkmcnt(0)
    v_mfma_f32_16x16x32_bf16 v[188:191], v[68:71], v[128:131], 0
    v_mfma_f32_16x16x32_bf16 v[204:207], v[68:71], v[136:139], 0
    v_mfma_f32_16x16x32_bf16 v[188:191], v[72:75], v[132:135], v[188:191]
    v_mfma_f32_16x16x32_bf16 v[204:207], v[72:75], v[140:143], v[204:207]
    v_mfma_f32_16x16x32_bf16 v[176:179], v[48:51], v[128:131], 0
    v_mfma_f32_16x16x32_bf16 v[192:195], v[48:51], v[136:139], 0
    v_mfma_f32_16x16x32_bf16 v[180:183], v[52:55], v[128:131], 0
    v_mfma_f32_16x16x32_bf16 v[196:199], v[52:55], v[136:139], 0
    v_mfma_f32_16x16x32_bf16 v[180:183], v[56:59], v[132:135], v[180:183]
    v_mfma_f32_16x16x32_bf16 v[196:199], v[56:59], v[140:143], v[196:199]
    v_mfma_f32_16x16x32_bf16 v[184:187], v[60:63], v[128:131], 0
    v_mfma_f32_16x16x32_bf16 v[200:203], v[60:63], v[136:139], 0
    v_mfma_f32_16x16x32_bf16 v[184:187], v[64:67], v[132:135], v[184:187]
    v_mfma_f32_16x16x32_bf16 v[200:203], v[64:67], v[140:143], v[200:203]
    v_add_f32 v188, s64, v188
    v_add_f32 v189, s64, v189
    v_rcp_f32 v208, v188
    v_rcp_f32 v210, v189
    s_nop 0
    v_cndmask_b32 v212, v210, v208, s[68:69]
    v_add_f32 v204, s64, v204
    v_add_f32 v205, s64, v205
    v_rcp_f32 v216, v204
    v_rcp_f32 v218, v205
    s_nop 0
    v_cndmask_b32 v220, v218, v216, s[68:69]
    v_pk_mul_f32 v[176:177], v[176:177], v[208:209] op_sel_hi:[1,0]
    v_cvt_pk_bf16_f32 v224, v176, v177
    v_pk_mul_f32 v[178:179], v[178:179], v[208:209] op_sel_hi:[1,0]
    v_cvt_pk_bf16_f32 v225, v178, v179
    v_pk_mul_f32 v[180:181], v[180:181], v[212:213] op_sel_hi:[1,0]
    v_cvt_pk_bf16_f32 v226, v180, v181
    v_pk_mul_f32 v[182:183], v[182:183], v[212:213] op_sel_hi:[1,0]
    v_cvt_pk_bf16_f32 v227, v182, v183
    v_pk_mul_f32 v[184:185], v[184:185], v[210:211] op_sel_hi:[1,0]
    v_cvt_pk_bf16_f32 v232, v184, v185
    v_pk_mul_f32 v[186:187], v[186:187], v[210:211] op_sel_hi:[1,0]
    v_cvt_pk_bf16_f32 v233, v186, v187
    buffer_store_dwordx4 v[224:227], v1, s[4:7], s96 offen sc1
    v_pk_mul_f32 v[192:193], v[192:193], v[216:217] op_sel_hi:[1,0]
    v_cvt_pk_bf16_f32 v228, v192, v193
    v_pk_mul_f32 v[194:195], v[194:195], v[216:217] op_sel_hi:[1,0]
    v_cvt_pk_bf16_f32 v229, v194, v195
    v_pk_mul_f32 v[196:197], v[196:197], v[220:221] op_sel_hi:[1,0]
    v_cvt_pk_bf16_f32 v230, v196, v197
    v_pk_mul_f32 v[198:199], v[198:199], v[220:221] op_sel_hi:[1,0]
    v_cvt_pk_bf16_f32 v231, v198, v199
    v_pk_mul_f32 v[200:201], v[200:201], v[218:219] op_sel_hi:[1,0]
    v_cvt_pk_bf16_f32 v234, v200, v201
    v_pk_mul_f32 v[202:203], v[202:203], v[218:219] op_sel_hi:[1,0]
    v_cvt_pk_bf16_f32 v235, v202, v203
    buffer_store_dwordx4 v[228:231], v1, s[4:7], s97 offen sc1
    v_permlane16_swap_b32 v232, v234
    v_permlane16_swap_b32 v233, v235
    s_mov_b64 exec, 0xffffffff
    buffer_store_dwordx4 v[232:235], v14, s[4:7], s98 offen sc1
    s_mov_b64 exec, -1
    s_add_u32 s45, s45, 16
    s_waitcnt vmcnt(0) lgkmcnt(0)
    s_barrier
    s_cmp_lg_u32 s18, 0
    s_cbranch_scc1 L_noarr_57
    v_mov_b32 v19, 1
    s_mov_b64 exec, 1
    buffer_atomic_add v19, v5, s[4:7], 0 offen sc1
    s_mov_b64 exec, -1
L_noarr_57:
    s_add_u32 m0, s42, 16384
    s_add_u32 s43, s95, 16384
    buffer_load_dwordx4 v2, s[4:7], s43 offen sc1 lds
    buffer_load_dwordx4 v2, s[4:7], s43 offen offset:1024 sc1 lds
    s_add_u32 m0, s42, 24576
    s_add_u32 s43, s95, 24576
    buffer_load_dwordx4 v2, s[4:7], s43 offen sc1 lds
    buffer_load_dwordx4 v2, s[4:7], s43 offen offset:1024 sc1 lds
    s_add_u32 m0, s42, 32768
    s_add_u32 s43, s95, 32768
    buffer_load_dwordx4 v2, s[4:7], s43 offen sc1 lds
    buffer_load_dwordx4 v2, s[4:7], s43 offen offset:1024 sc1 lds
    s_add_u32 m0, s42, 40960
    s_add_u32 s43, s95, 40960
    buffer_load_dwordx4 v2, s[4:7], s43 offen sc1 lds
    buffer_load_dwordx4 v2, s[4:7], s43 offen offset:1024 sc1 lds
    s_add_u32 m0, s42, 49152
    s_add_u32 s43, s95, 49152
    buffer_load_dwordx4 v2, s[4:7], s43 offen sc1 lds
    buffer_load_dwordx4 v2, s[4:7], s43 offen offset:1024 sc1 lds
    s_add_u32 m0, s42, 57344
    s_add_u32 s43, s95, 57344
    buffer_load_dwordx4 v2, s[4:7], s43 offen sc1 lds
    buffer_load_dwordx4 v2, s[4:7], s43 offen offset:1024 sc1 lds
    s_mul_i32 s56, s41, 2621440
    s_sub_u32 s3, s71, s18
    s_mul_i32 s3, s3, 20480
    s_add_u32 s56, s56, s3
    s_mul_i32 s3, s18, 5120
    s_add_u32 s56, s56, s3
    s_add_u32 s56, s56, 23977984
    s_add_u32 s3, s18, 1
    s_and_b32 s3, s3, 3
    s_mul_i32 s58, s3, 20480
    s_add_u32 s58, s58, s56
    s_mul_i32 s3, s3, 15360
    s_add_u32 s3, s3, 98304
    v_add_u32 v10, s3, v1
    s_add_u32 s3, s18, 2
    s_and_b32 s3, s3, 3
    s_mul_i32 s59, s3, 20480
    s_add_u32 s59, s59, s56
    s_mul_i32 s3, s3, 15360
    s_add_u32 s3, s3, 103424
    v_add_u32 v11, s3, v1
    s_add_u32 s3, s18, 3
    s_and_b32 s3, s3, 3
    s_mul_i32 s60, s3, 20480
    s_add_u32 s60, s60, s56
    s_mul_i32 s3, s3, 15360
    s_add_u32 s3, s3, 108544
    v_add_u32 v12, s3, v1
    s_add_u32 s3, s18, 4
    s_and_b32 s3, s3, 3
    s_mul_i32 s61, s3, 20480
    s_add_u32 s61, s61, s56
    s_mul_i32 s3, s3, 15360
    s_add_u32 s3, s3, 98304
    v_add_u32 v13, s3, v1
    s_cmp_lg_u32 s18, 0
    s_cbranch_scc1 L_nopoll_58
    s_mov_b64 exec, 1
    s_mov_b32 s47, 0
L_poll_59:
    buffer_load_dword v19, v5, s[4:7], 0 offen sc1
    s_add_u32 s47, s47, 1
    s_cmp_gt_u32 s47, 0x40000
    s_cbranch_scc1 L_pollout_60
    s_waitcnt vmcnt(0)
    v_cmp_gt_u32 vcc, s45, v19
    s_nop 0
    s_cbranch_vccnz L_poll_59
L_pollout_60:
    s_mov_b64 exec, -1
L_nopoll_58:
    s_barrier
    buffer_load_dwordx4 v[40:43], v1, s[4:7], s58 offen offset:0 sc1
    buffer_load_dwordx4 v[44:47], v1, s[4:7], s58 offen offset:1024 sc1
    buffer_load_dwordx4 v[48:51], v1, s[4:7], s58 offen offset:2048 sc1
    buffer_load_dwordx4 v[52:55], v1, s[4:7], s58 offen offset:3072 sc1
    s_add_u32 s58, s58, 4096
    buffer_load_dwordx4 v[56:59], v1, s[4:7], s58 offen offset:0 sc1
    buffer_load_dwordx4 v[60:63], v1, s[4:7], s59 offen offset:0 sc1
    buffer_load_dwordx4 v[64:67], v1, s[4:7], s59 offen offset:1024 sc1
    buffer_load_dwordx4 v[68:71], v1, s[4:7], s59 offen offset:2048 sc1
    buffer_load_dwordx4 v[72:75], v1, s[4:7], s59 offen offset:3072 sc1
    s_add_u32 s59, s59, 4096
    buffer_load_dwordx4 v[76:79], v1, s[4:7], s59 offen offset:0 sc1
    s_waitcnt vmcnt(9)
    v_mfma_f32_16x16x32_bf16 v[120:123], a[0:3], v[40:43], 0
    buffer_load_dwordx4 v[80:83], v1, s[4:7], s60 offen offset:0 sc1
    v_mfma_f32_16x16x32_bf16 v[124:127], a[4:7], v[40:43], 0
    buffer_load_dwordx4 v[84:87], v1, s[4:7], s60 offen offset:1024 sc1
    v_mfma_f32_16x16x32_bf16 v[128:131], a[8:11], v[40:43], 0
    v_mfma_f32_16x16x32_bf16 v[132:135], a[12:15], v[40:43], 0
    v_mfma_f32_16x16x32_bf16 v[136:139], a[16:19], v[40:43], 0
    s_waitcnt vmcnt(10)
    v_mfma_f32_16x16x32_bf16 v[120:123], a[20:23], v[44:47], v[120:123]
    buffer_load_dwordx4 v[88:91], v1, s[4:7], s60 offen offset:2048 sc1
    v_mfma_f32_16x16x32_bf16 v[124:127], a[24:27], v[44:47], v[124:127]
    v_mfma_f32_16x16x32_bf16 v[128:131], a[28:31], v[44:47], v[128:131]
    v_mfma_f32_16x16x32_bf16 v[132:135], a[32:35], v[44:47], v[132:135]
    v_mfma_f32_16x16x32_bf16 v[136:139], a[36:39], v[44:47], v[136:139]
    s_waitcnt vmcnt(10)
    v_mfma_f32_16x16x32_bf16 v[120:123], a[40:43], v[48:51], v[120:123]
    buffer_load_dwordx4 v[92:95], v1, s[4:7], s60 offen offset:3072 sc1
    v_mfma_f32_16x16x32_bf16 v[124:127], a[44:47], v[48:51], v[124:127]
    v_mfma_f32_16x16x32_bf16 v[128:131], a[48:51], v[48:51], v[128:131]
    v_mfma_f32_16x16x32_bf16 v[132:135], a[52:55], v[48:51], v[132:135]
    v_mfma_f32_16x16x32_bf16 v[136:139], a[56:59], v[48:51], v[136:139]
    s_waitcnt vmcnt(10)
    v_mfma_f32_16x16x32_bf16 v[120:123], a[60:63], v[52:55], v[120:123]
    s_add_u32 s60, s60, 4096
    v_mfma_f32_16x16x32_bf16 v[124:127], a[64:67], v[52:55], v[124:127]
    buffer_load_dwordx4 v[96:99], v1, s[4:7], s60 offen offset:0 sc1
    v_mfma_f32_16x16x32_bf16 v[128:131], a[68:71], v[52:55], v[128:131]
    buffer_load_dwordx4 v[100:103], v1, s[4:7], s61 offen offset:0 sc1
    v_mfma_f32_16x16x32_bf16 v[132:135], a[72:75], v[52:55], v[132:135]
    v_mfma_f32_16x16x32_bf16 v[136:139], a[76:79], v[52:55], v[136:139]
    s_waitcnt vmcnt(11)
    v_mfma_f32_16x16x32_bf16 v[120:123], a[80:83], v[56:59], v[120:123]
    buffer_load_dwordx4 v[104:107], v1, s[4:7], s61 offen offset:1024 sc1
    v_mfma_f32_16x16x32_bf16 v[124:127], a[84:87], v[56:59], v[124:127]
    v_mfma_f32_16x16x32_bf16 v[128:131], a[88:91], v[56:59], v[128:131]
    v_mfma_f32_16x16x32_bf16 v[132:135], a[92:95], v[56:59], v[132:135]
    v_mfma_f32_16x16x32_bf16 v[136:139], a[96:99], v[56:59], v[136:139]
    s_waitcnt vmcnt(11)
    v_mfma_f32_16x16x32_bf16 v[140:143], a[0:3], v[60:63], 0
    buffer_load_dwordx4 v[108:111], v1, s[4:7], s61 offen offset:2048 sc1
    v_mfma_f32_16x16x32_bf16 v[144:147], a[4:7], v[60:63], 0
    v_mfma_f32_16x16x32_bf16 v[148:151], a[8:11], v[60:63], 0
    v_mfma_f32_16x16x32_bf16 v[152:155], a[12:15], v[60:63], 0
    v_mfma_f32_16x16x32_bf16 v[156:159], a[16:19], v[60:63], 0
    s_waitcnt vmcnt(11)
    v_mfma_f32_16x16x32_bf16 v[140:143], a[20:23], v[64:67], v[140:143]
    buffer_load_dwordx4 v[112:115], v1, s[4:7], s61 offen offset:3072 sc1
    v_mfma_f32_16x16x32_bf16 v[144:147], a[24:27], v[64:67], v[144:147]
    s_add_u32 s61, s61, 4096
    v_mfma_f32_16x16x32_bf16 v[148:151], a[28:31], v[64:67], v[148:151]
    buffer_load_dwordx4 v[116:119], v1, s[4:7], s61 offen offset:0 sc1
    v_mfma_f32_16x16x32_bf16 v[152:155], a[32:35], v[64:67], v[152:155]
    ds_write_b128 v10, v[120:123] offset:0
    v_mfma_f32_16x16x32_bf16 v[156:159], a[36:39], v[64:67], v[156:159]
    s_waitcnt vmcnt(12)
    v_mfma_f32_16x16x32_bf16 v[140:143], a[40:43], v[68:71], v[140:143]
    ds_write_b128 v10, v[124:127] offset:1024
    v_mfma_f32_16x16x32_bf16 v[144:147], a[44:47], v[68:71], v[144:147]
    ds_write_b128 v10, v[128:131] offset:2048
    v_mfma_f32_16x16x32_bf16 v[148:151], a[48:51], v[68:71], v[148:151]
    ds_write_b128 v10, v[132:135] offset:3072
    v_mfma_f32_16x16x32_bf16 v[152:155], a[52:55], v[68:71], v[152:155]
    ds_write_b128 v10, v[136:139] offset:4096
    v_mfma_f32_16x16x32_bf16 v[156:159], a[56:59], v[68:71], v[156:159]
    s_waitcnt vmcnt(11)
    v_mfma_f32_16x16x32_bf16 v[140:143], a[60:63], v[72:75], v[140:143]
    s_add_u32 m0, s42, 90112
    s_add_u32 s43, s95, 90112
    v_mfma_f32_16x16x32_bf16 v[144:147], a[64:67], v[72:75], v[144:147]
    buffer_load_dwordx4 v2, s[4:7], s43 offen sc1 lds
    v_mfma_f32_16x16x32_bf16 v[148:151], a[68:71], v[72:75], v[148:151]
    buffer_load_dwordx4 v2, s[4:7], s43 offen offset:1024 sc1 lds
    v_mfma_f32_16x16x32_bf16 v[152:155], a[72:75], v[72:75], v[152:155]
    v_mfma_f32_16x16x32_bf16 v[156:159], a[76:79], v[72:75], v[156:159]
    s_waitcnt vmcnt(12)
    v_mfma_f32_16x16x32_bf16 v[140:143], a[80:83], v[76:79], v[140:143]
    s_add_u32 s62, s70, 12288
    v_mfma_f32_16x16x32_bf16 v[144:147], a[84:87], v[76:79], v[144:147]
    buffer_load_dwordx4 a[224:227], v1, s[4:7], s62 offen offset:0 sc1
    v_mfma_f32_16x16x32_bf16 v[148:151], a[88:91], v[76:79], v[148:151]
    buffer_load_dwordx4 a[228:231], v1, s[4:7], s62 offen offset:1024 sc1
    v_mfma_f32_16x16x32_bf16 v[152:155], a[92:95], v[76:79], v[152:155]
    v_mfma_f32_16x16x32_bf16 v[156:159], a[96:99], v[76:79], v[156:159]
    s_waitcnt vmcnt(13)
    v_mfma_f32_16x16x32_bf16 v[120:123], a[0:3], v[80:83], 0
    buffer_load_dwordx4 a[232:235], v1, s[4:7], s62 offen offset:2048 sc1
    v_mfma_f32_16x16x32_bf16 v[124:127], a[4:7], v[80:83], 0
    buffer_load_dwordx4 a[236:239], v1, s[4:7], s62 offen offset:3072 sc1
    v_mfma_f32_16x16x32_bf16 v[128:131], a[8:11], v[80:83], 0
    v_mfma_f32_16x16x32_bf16 v[132:135], a[12:15], v[80:83], 0
    v_mfma_f32_16x16x32_bf16 v[136:139], a[16:19], v[80:83], 0
    s_waitcnt vmcnt(14)
    v_mfma_f32_16x16x32_bf16 v[120:123], a[20:23], v[84:87], v[120:123]
    ds_write_b128 v11, v[140:143] offset:0
    v_mfma_f32_16x16x32_bf16 v[124:127], a[24:27], v[84:87], v[124:127]
    ds_write_b128 v11, v[144:147] offset:1024
    v_mfma_f32_16x16x32_bf16 v[128:131], a[28:31], v[84:87], v[128:131]
    ds_write_b128 v11, v[148:151] offset:2048
    v_mfma_f32_16x16x32_bf16 v[132:135], a[32:35], v[84:87], v[132:135]
    ds_write_b128 v11, v[152:155] offset:3072
    v_mfma_f32_16x16x32_bf16 v[136:139], a[36:39], v[84:87], v[136:139]
    s_waitcnt vmcnt(13)
    s_add_u32 s62, s70, 16384
    v_mfma_f32_16x16x32_bf16 v[120:123], a[40:43], v[88:91], v[120:123]
    ds_write_b128 v11, v[156:159] offset:4096
    v_mfma_f32_16x16x32_bf16 v[124:127], a[44:47], v[88:91], v[124:127]
    buffer_load_dwordx4 a[240:243], v1, s[4:7], s62 offen offset:0 sc1
    v_mfma_f32_16x16x32_bf16 v[128:131], a[48:51], v[88:91], v[128:131]
    buffer_load_dwordx4 a[244:247], v1, s[4:7], s62 offen offset:1024 sc1
    v_mfma_f32_16x16x32_bf16 v[132:135], a[52:55], v[88:91], v[132:135]
    buffer_load_dwordx4 a[248:251], v1, s[4:7], s62 offen offset:2048 sc1
    v_mfma_f32_16x16x32_bf16 v[136:139], a[56:59], v[88:91], v[136:139]
    s_waitcnt vmcnt(15)
    v_mfma_f32_16x16x32_bf16 v[120:123], a[60:63], v[92:95], v[120:123]
    buffer_load_dwordx4 a[252:255], v1, s[4:7], s62 offen offset:3072 sc1
    v_mfma_f32_16x16x32_bf16 v[124:127], a[64:67], v[92:95], v[124:127]
    s_add_u32 s62, s70, 20480
    v_mfma_f32_16x16x32_bf16 v[128:131], a[68:71], v[92:95], v[128:131]
    buffer_load_dwordx4 a[100:103], v1, s[4:7], s62 offen offset:0 sc1
    v_mfma_f32_16x16x32_bf16 v[132:135], a[72:75], v[92:95], v[132:135]
    v_mfma_f32_16x16x32_bf16 v[136:139], a[76:79], v[92:95], v[136:139]
    s_waitcnt vmcnt(16)
    v_mfma_f32_16x16x32_bf16 v[120:123], a[80:83], v[96:99], v[120:123]
    buffer_load_dwordx4 a[104:107], v1, s[4:7], s62 offen offset:1024 sc1
    v_mfma_f32_16x16x32_bf16 v[124:127], a[84:87], v[96:99], v[124:127]
    v_mfma_f32_16x16x32_bf16 v[128:131], a[88:91], v[96:99], v[128:131]
    v_mfma_f32_16x16x32_bf16 v[132:135], a[92:95], v[96:99], v[132:135]
    v_mfma_f32_16x16x32_bf16 v[136:139], a[96:99], v[96:99], v[136:139]
    s_waitcnt vmcnt(16)
    v_mfma_f32_16x16x32_bf16 v[140:143], a[0:3], v[100:103], 0
    buffer_load_dwordx4 a[108:111], v1, s[4:7], s62 offen offset:2048 sc1
    v_mfma_f32_16x16x32_bf16 v[144:147], a[4:7], v[100:103], 0
    buffer_load_dwordx4 a[112:115], v1, s[4:7], s62 offen offset:3072 sc1
    v_mfma_f32_16x16x32_bf16 v[148:151], a[8:11], v[100:103], 0
    v_mfma_f32_16x16x32_bf16 v[152:155], a[12:15], v[100:103], 0
    v_mfma_f32_16x16x32_bf16 v[156:159], a[16:19], v[100:103], 0
    s_waitcnt vmcnt(17)
    v_mfma_f32_16x16x32_bf16 v[140:143], a[20:23], v[104:107], v[140:143]
    ds_write_b128 v12, v[120:123] offset:0
    v_mfma_f32_16x16x32_bf16 v[144:147], a[24:27], v[104:107], v[144:147]
    ds_write_b128 v12, v[124:127] offset:1024
    v_mfma_f32_16x16x32_bf16 v[148:151], a[28:31], v[104:107], v[148:151]
    ds_write_b128 v12, v[128:131] offset:2048
    v_mfma_f32_16x16x32_bf16 v[152:155], a[32:35], v[104:107], v[152:155]
    ds_write_b128 v12, v[132:135] offset:3072
    v_mfma_f32_16x16x32_bf16 v[156:159], a[36:39], v[104:107], v[156:159]
    s_waitcnt vmcnt(16)
    s_add_u32 s62, s70, 24576
    v_mfma_f32_16x16x32_bf16 v[140:143], a[40:43], v[108:111], v[140:143]
    ds_write_b128 v12, v[136:139] offset:4096
    v_mfma_f32_16x16x32_bf16 v[144:147], a[44:47], v[108:111], v[144:147]
    s_waitcnt lgkmcnt(0)
    s_barrier
    v_mfma_f32_16x16x32_bf16 v[148:151], a[48:51], v[108:111], v[148:151]
    ds_read_b128 v[40:43], v13 offset:0
    ds_read_b128 v[44:47], v13 offset:1024
    v_mfma_f32_16x16x32_bf16 v[152:155], a[52:55], v[108:111], v[152:155]
    ds_read_b128 v[48:51], v13 offset:2048
    ds_read_b128 v[52:55], v13 offset:3072
    v_mfma_f32_16x16x32_bf16 v[156:159], a[56:59], v[108:111], v[156:159]
    s_waitcnt vmcnt(15)
    ds_read_b128 v[56:59], v13 offset:4096
    v_mfma_f32_16x16x32_bf16 v[140:143], a[60:63], v[112:115], v[140:143]
    ds_read_b128 v[60:63], v13 offset:5120
    ds_read_b128 v[64:67], v13 offset:6144
    v_mfma_f32_16x16x32_bf16 v[144:147], a[64:67], v[112:115], v[144:147]
    ds_read_b128 v[68:71], v13 offset:7168
    ds_read_b128 v[72:75], v13 offset:8192
    v_mfma_f32_16x16x32_bf16 v[148:151], a[68:71], v[112:115], v[148:151]
    ds_read_b128 v[76:79], v13 offset:9216
    ds_read_b128 v[80:83], v13 offset:10240
    v_mfma_f32_16x16x32_bf16 v[152:155], a[72:75], v[112:115], v[152:155]
    ds_read_b128 v[84:87], v13 offset:11264
    ds_read_b128 v[88:91], v13 offset:12288
    v_mfma_f32_16x16x32_bf16 v[156:159], a[76:79], v[112:115], v[156:159]
    s_waitcnt vmcnt(14)
    ds_read_b128 v[92:95], v13 offset:13312
    v_mfma_f32_16x16x32_bf16 v[140:143], a[80:83], v[116:119], v[140:143]
    ds_read_b128 v[96:99], v13 offset:14336
    v_mfma_f32_16x16x32_bf16 v[144:147], a[84:87], v[116:119], v[144:147]
    buffer_load_dwordx4 a[116:119], v1, s[4:7], s62 offen offset:0 sc1
    v_mfma_f32_16x16x32_bf16 v[148:151], a[88:91], v[116:119], v[148:151]
    buffer_load_dwordx4 a[120:123], v1, s[4:7], s62 offen offset:1024 sc1
    v_mfma_f32_16x16x32_bf16 v[152:155], a[92:95], v[116:119], v[152:155]
    buffer_load_dwordx4 a[124:127], v1, s[4:7], s62 offen offset:2048 sc1
    v_mfma_f32_16x16x32_bf16 v[156:159], a[96:99], v[116:119], v[156:159]
    buffer_load_dwordx4 a[128:131], v1, s[4:7], s62 offen offset:3072 sc1
    s_add_u32 s62, s70, 28672
    buffer_load_dwordx4 a[132:135], v1, s[4:7], s62 offen offset:0 sc1
    buffer_load_dwordx4 a[136:139], v1, s[4:7], s62 offen offset:1024 sc1
    s_waitcnt lgkmcnt(10)
    v_pk_add_f32 v[20:21], v[20:21], v[40:41]
    v_pk_add_f32 v[22:23], v[22:23], v[42:43]
    v_pk_add_f32 v[24:25], v[24:25], v[44:45]
    v_pk_add_f32 v[26:27], v[26:27], v[46:47]
    v_pk_add_f32 v[28:29], v[28:29], v[48:49]
    v_pk_add_f32 v[30:31], v[30:31], v[50:51]
    v_pk_add_f32 v[32:33], v[32:33], v[52:53]
    v_pk_add_f32 v[34:35], v[34:35], v[54:55]
    v_pk_add_f32 v[36:37], v[36:37], v[56:57]
    v_pk_add_f32 v[38:39], v[38:39], v[58:59]
    s_waitcnt lgkmcnt(5)
    v_pk_add_f32 v[20:21], v[20:21], v[60:61]
    v_pk_add_f32 v[22:23], v[22:23], v[62:63]
    v_pk_add_f32 v[24:25], v[24:25], v[64:65]
    v_pk_add_f32 v[26:27], v[26:27], v[66:67]
    v_pk_add_f32 v[28:29], v[28:29], v[68:69]
    v_pk_add_f32 v[30:31], v[30:31], v[70:71]
    v_pk_add_f32 v[32:33], v[32:33], v[72:73]
    v_pk_add_f32 v[34:35], v[34:35], v[74:75]
    v_pk_add_f32 v[36:37], v[36:37], v[76:77]
    v_pk_add_f32 v[38:39], v[38:39], v[78:79]
    s_waitcnt lgkmcnt(0)
    v_pk_add_f32 v[20:21], v[20:21], v[80:81]
    v_pk_add_f32 v[22:23], v[22:23], v[82:83]
    v_pk_add_f32 v[24:25], v[24:25], v[84:85]
    v_pk_add_f32 v[26:27], v[26:27], v[86:87]
    v_pk_add_f32 v[28:29], v[28:29], v[88:89]
    v_pk_add_f32 v[30:31], v[30:31], v[90:91]
    v_pk_add_f32 v[32:33], v[32:33], v[92:93]
    v_pk_add_f32 v[34:35], v[34:35], v[94:95]
    v_pk_add_f32 v[36:37], v[36:37], v[96:97]
    v_pk_add_f32 v[38:39], v[38:39], v[98:99]
    v_pk_add_f32 v[20:21], v[20:21], v[140:141]
    v_pk_add_f32 v[22:23], v[22:23], v[142:143]
    v_pk_add_f32 v[24:25], v[24:25], v[144:145]
    v_pk_add_f32 v[26:27], v[26:27], v[146:147]
    v_pk_add_f32 v[28:29], v[28:29], v[148:149]
    v_pk_add_f32 v[30:31], v[30:31], v[150:151]
    v_pk_add_f32 v[32:33], v[32:33], v[152:153]
    v_pk_add_f32 v[34:35], v[34:35], v[154:155]
    v_pk_add_f32 v[36:37], v[36:37], v[156:157]
    v_pk_add_f32 v[38:39], v[38:39], v[158:159]
    v_cvt_pk_bf16_f32 v100, v20, v21
    v_cvt_pk_bf16_f32 v101, v22, v23
    v_cvt_pk_bf16_f32 v102, v24, v25
    v_cvt_pk_bf16_f32 v103, v26, v27
    v_cvt_pk_bf16_f32 v104, v28, v29
    v_cvt_pk_bf16_f32 v105, v30, v31
    v_cvt_pk_bf16_f32 v106, v32, v33
    v_cvt_pk_bf16_f32 v107, v34, v35
    v_cvt_pk_bf16_f32 v108, v36, v37
    v_cvt_pk_bf16_f32 v109, v38, v39
    v_mov_b32 v110, v108
    v_mov_b32 v111, v109
    s_mul_i32 s52, s44, 2621440
    s_mul_i32 s53, s71, 20480
    s_add_u32 s52, s52, s53
    s_add_u32 s52, s52, 13492224
    s_lshl_b32 s53, s19, 11
    s_add_u32 s96, s53, s52
    buffer_store_dwordx4 v[100:103], v1, s[4:7], s96 offen sc1
    buffer_store_dwordx4 v[104:107], v1, s[4:7], s96 offen offset:1024 sc1
    v_lshlrev_b32 v20, 16, v100
    v_and_b32 v21, 0xffff0000, v100
    v_lshlrev_b32 v22, 16, v101
    v_and_b32 v23, 0xffff0000, v101
    v_lshlrev_b32 v24, 16, v102
    v_and_b32 v25, 0xffff0000, v102
    v_lshlrev_b32 v26, 16, v103
    v_and_b32 v27, 0xffff0000, v103
    v_lshlrev_b32 v28, 16, v104
    v_and_b32 v29, 0xffff0000, v104
    v_lshlrev_b32 v30, 16, v105
    v_and_b32 v31, 0xffff0000, v105
    v_lshlrev_b32 v32, 16, v106
    v_and_b32 v33, 0xffff0000, v106
    v_lshlrev_b32 v34, 16, v107
    v_and_b32 v35, 0xffff0000, v107
    v_lshlrev_b32 v36, 16, v108
    v_and_b32 v37, 0xffff0000, v108
    v_lshlrev_b32 v38, 16, v109
    v_and_b32 v39, 0xffff0000, v109
    v_permlane16_swap_b32 v108, v110
    v_permlane16_swap_b32 v109, v111
    s_lshr_b32 s53, s19, 1
    s_lshl_b32 s53, s53, 10
    s_and_b32 s3, s19, 1
    s_lshl_b32 s3, s3, 9
    s_add_u32 s53, s53, s3
    s_add_u32 s53, s53, s52
    s_add_u32 s97, s53, 16384
    v_and_b32 v10, 15, v0
    v_lshrrev_b32 v11, 5, v0
    v_lshl_add_u32 v11, v11, 4, v10
    v_lshlrev_b32 v11, 4, v11
    s_mov_b32 exec_lo, 0xffff
    s_mov_b32 exec_hi, 0xffff
    buffer_store_dwordx4 v[108:111], v11, s[4:7], s97 offen sc1
    s_mov_b64 exec, -1
    v_pk_add_f32 v[12:13], v[20:21], v[22:23]
    v_pk_mul_f32 v[14:15], v[20:21], v[20:21]
    v_pk_fma_f32 v[14:15], v[22:23], v[22:23], v[14:15]
    v_pk_add_f32 v[12:13], v[12:13], v[24:25]
    v_pk_fma_f32 v[14:15], v[24:25], v[24:25], v[14:15]
    v_pk_add_f32 v[12:13], v[12:13], v[26:27]
    v_pk_fma_f32 v[14:15], v[26:27], v[26:27], v[14:15]
    v_pk_add_f32 v[12:13], v[12:13], v[28:29]
    v_pk_fma_f32 v[14:15], v[28:29], v[28:29], v[14:15]
    v_pk_add_f32 v[12:13], v[12:13], v[30:31]
    v_pk_fma_f32 v[14:15], v[30:31], v[30:31], v[14:15]
    v_pk_add_f32 v[12:13], v[12:13], v[32:33]
    v_pk_fma_f32 v[14:15], v[32:33], v[32:33], v[14:15]
    v_pk_add_f32 v[12:13], v[12:13], v[34:35]
    v_pk_fma_f32 v[14:15], v[34:35], v[34:35], v[14:15]
    v_pk_add_f32 v[12:13], v[12:13], v[36:37]
    v_pk_fma_f32 v[14:15], v[36:37], v[36:37], v[14:15]
    v_pk_add_f32 v[12:13], v[12:13], v[38:39]
    v_pk_fma_f32 v[14:15], v[38:39], v[38:39], v[14:15]
    v_add_f32 v12, v12, v13
    v_add_f32 v13, v14, v15
    v_mov_b32 v14, v12
    v_mov_b32 v15, v13
    s_nop 0
    v_permlane16_swap_b32 v12, v14
    v_permlane16_swap_b32 v13, v15
    v_add_f32 v12, v12, v14
    v_add_f32 v13, v13, v15
    v_mov_b32 v14, v12
    v_mov_b32 v15, v13
    s_nop 0
    v_permlane32_swap_b32 v12, v14
    v_permlane32_swap_b32 v13, v15
    v_add_f32 v12, v12, v14
    v_add_f32 v13, v13, v15
    s_mul_i32 s52, s44, 131072
    s_lshl_b32 s53, s71, 10
    s_add_u32 s52, s52, s53
    s_lshl_b32 s53, s19, 7
    s_add_u32 s52, s52, s53
    s_add_u32 s98, s52, 622592
    v_lshlrev_b32 v10, 3, v10
    s_mov_b64 exec, s[68:69]
    buffer_store_dwordx2 v[12:13], v10, s[4:7], s98 offen sc1
    s_mov_b64 exec, -1
    s_add_u32 s44, s44, 1
    s_add_u32 s45, s45, 16
    s_waitcnt vmcnt(0) lgkmcnt(0)
    s_barrier
    s_cmp_lg_u32 s18, 0
    s_cbranch_scc1 L_noarr_61
    v_mov_b32 v19, 1
    s_mov_b64 exec, 1
    buffer_atomic_add v19, v5, s[4:7], 0 offen sc1
    s_mov_b64 exec, -1
L_noarr_61:
    s_add_u32 m0, s42, 98304
    s_add_u32 s43, s95, 98304
    buffer_load_dwordx4 v2, s[4:7], s43 offen sc1 lds
    buffer_load_dwordx4 v2, s[4:7], s43 offen offset:1024 sc1 lds
    s_add_u32 m0, s42, 106496
    s_add_u32 s43, s95, 106496
    buffer_load_dwordx4 v2, s[4:7], s43 offen sc1 lds
    buffer_load_dwordx4 v2, s[4:7], s43 offen offset:1024 sc1 lds
    s_add_u32 m0, s42, 114688
    s_add_u32 s43, s95, 114688
    buffer_load_dwordx4 v2, s[4:7], s43 offen sc1 lds
    buffer_load_dwordx4 v2, s[4:7], s43 offen offset:1024 sc1 lds
    s_add_u32 m0, s42, 122880
    s_add_u32 s43, s95, 122880
    buffer_load_dwordx4 v2, s[4:7], s43 offen sc1 lds
    buffer_load_dwordx4 v2, s[4:7], s43 offen offset:1024 sc1 lds
    s_add_u32 m0, s42, 131072
    s_add_u32 s43, s95, 131072
    buffer_load_dwordx4 v2, s[4:7], s43 offen sc1 lds
    buffer_load_dwordx4 v2, s[4:7], s43 offen offset:1024 sc1 lds
    s_add_u32 m0, s42, 139264
    s_add_u32 s43, s95, 139264
    buffer_load_dwordx4 v2, s[4:7], s43 offen sc1 lds
    buffer_load_dwordx4 v2, s[4:7], s43 offen offset:1024 sc1 lds
    s_sub_u32 s58, s44, 1
    s_mul_i32 s58, s58, 2621440
    s_mul_i32 s3, s72, 20480
    s_add_u32 s58, s58, s3
    s_add_u32 s58, s58, 13492224
    s_add_u32 s59, s58, 20480
    s_sub_u32 s52, s44, 1
    s_mul_i32 s52, s52, 131072
    s_lshl_b32 s53, s72, 10
    s_add_u32 s52, s52, s53
    s_add_u32 s52, s52, 622592
    v_and_b32 v18, 15, v0
    v_lshlrev_b32 v18, 3, v18
    v_and_b32 v17, 48, v0
    v_lshl_add_u32 v18, v17, 4, v18
    s_cmp_lg_u32 s18, 0
    s_cbranch_scc1 L_nopoll_62
    s_mov_b64 exec, 1
    s_mov_b32 s47, 0
L_poll_63:
    buffer_load_dword v19, v5, s[4:7], 0 offen sc1
    s_add_u32 s47, s47, 1
    s_cmp_gt_u32 s47, 0x40000
    s_cbranch_scc1 L_pollout_64
    s_waitcnt vmcnt(0)
    v_cmp_gt_u32 vcc, s45, v19
    s_nop 0
    s_cbranch_vccnz L_poll_63
L_pollout_64:
    s_mov_b64 exec, -1
L_nopoll_62:
    s_barrier
    buffer_load_dwordx4 v[176:179], v1, s[4:7], s58 offen offset:0 sc1
    buffer_load_dwordx4 v[180:183], v1, s[4:7], s59 offen offset:0 sc1
    buffer_load_dwordx4 v[184:187], v1, s[4:7], s58 offen offset:1024 sc1
    buffer_load_dwordx4 v[188:191], v1, s[4:7], s59 offen offset:1024 sc1
    buffer_load_dwordx2 v[10:11], v18, s[4:7], s52 offen offset:0 sc1
    buffer_load_dwordx2 v[12:13], v18, s[4:7], s52 offen offset:128 sc1
    buffer_load_dwordx2 v[14:15], v18, s[4:7], s52 offen offset:1024 sc1
    buffer_load_dwordx2 v[16:17], v18, s[4:7], s52 offen offset:1152 sc1
    buffer_load_dwordx4 v[192:195], v1, s[4:7], s58 offen offset:2048 sc1
    buffer_load_dwordx4 v[196:199], v1, s[4:7], s59 offen offset:2048 sc1
    s_barrier
    ds_read_b128 v[152:155], v1 offset:0
    ds_read_b128 v[156:159], v1 offset:1024
    ds_read_b128 v[160:163], v1 offset:2048
    ds_read_b128 v[164:167], v1 offset:3072
    ds_read_b128 v[168:171], v1 offset:4096
    s_waitcnt vmcnt(8) lgkmcnt(4)
    v_mfma_f32_16x16x32_bf16 v[40:43], v[152:155], v[176:179], 0
    ds_read_b128 v[172:175], v1 offset:5120
    s_waitcnt lgkmcnt(4)
    v_mfma_f32_16x16x32_bf16 v[44:47], v[152:155], v[180:183], 0
    buffer_load_dwordx4 v[200:203], v1, s[4:7], s58 offen offset:3072 sc1
    v_mfma_f32_16x16x32_bf16 v[48:51], v[156:159], v[176:179], 0
    ds_read_b128 v[152:155], v1 offset:6144
    s_waitcnt lgkmcnt(4)
    v_mfma_f32_16x16x32_bf16 v[52:55], v[156:159], v[180:183], 0
    buffer_load_dwordx4 v[204:207], v1, s[4:7], s59 offen offset:3072 sc1
    v_mfma_f32_16x16x32_bf16 v[56:59], v[160:163], v[176:179], 0
    ds_read_b128 v[156:159], v1 offset:7168
    s_waitcnt lgkmcnt(4)
    v_mfma_f32_16x16x32_bf16 v[60:63], v[160:163], v[180:183], 0
    v_mfma_f32_16x16x32_bf16 v[64:67], v[164:167], v[176:179], 0
    ds_read_b128 v[160:163], v1 offset:8192
    s_waitcnt lgkmcnt(4)
    v_mfma_f32_16x16x32_bf16 v[68:71], v[164:167], v[180:183], 0
    s_add_u32 s58, s58, 4096
    s_add_u32 s59, s59, 4096
    v_mfma_f32_16x16x32_bf16 v[72:75], v[168:171], v[176:179], 0
    ds_read_b128 v[164:167], v1 offset:9216
    s_waitcnt lgkmcnt(4)
    v_mfma_f32_16x16x32_bf16 v[76:79], v[168:171], v[180:183], 0
    buffer_load_dwordx4 v[208:211], v1, s[4:7], s58 offen offset:0 sc1
    v_mfma_f32_16x16x32_bf16 v[80:83], v[172:175], v[176:179], 0
    ds_read_b128 v[168:171], v1 offset:10240
    s_waitcnt lgkmcnt(4)
    v_mfma_f32_16x16x32_bf16 v[84:87], v[172:175], v[180:183], 0
    buffer_load_dwordx4 v[212:215], v1, s[4:7], s59 offen offset:0 sc1
    v_mfma_f32_16x16x32_bf16 v[88:91], v[152:155], v[176:179], 0
    ds_read_b128 v[172:175], v1 offset:11264
    s_waitcnt lgkmcnt(4)
    v_mfma_f32_16x16x32_bf16 v[92:95], v[152:155], v[180:183], 0
    v_mfma_f32_16x16x32_bf16 v[96:99], v[156:159], v[176:179], 0
    ds_read_b128 v[152:155], v1 offset:12288
    s_waitcnt lgkmcnt(4)
    v_mfma_f32_16x16x32_bf16 v[100:103], v[156:159], v[180:183], 0
    buffer_load_dwordx4 v[216:219], v1, s[4:7], s58 offen offset:1024 sc1
    v_mfma_f32_16x16x32_bf16 v[104:107], v[160:163], v[176:179], 0
    ds_read_b128 v[156:159], v1 offset:13312
    s_waitcnt lgkmcnt(4)
    v_mfma_f32_16x16x32_bf16 v[108:111], v[160:163], v[180:183], 0
    v_mfma_f32_16x16x32_bf16 v[112:115], v[164:167], v[176:179], 0
    ds_read_b128 v[160:163], v1 offset:14336
    s_waitcnt lgkmcnt(4)
    v_mfma_f32_16x16x32_bf16 v[116:119], v[164:167], v[180:183], 0
    buffer_load_dwordx4 v[220:223], v1, s[4:7], s59 offen offset:1024 sc1
    v_mfma_f32_16x16x32_bf16 v[120:123], v[168:171], v[176:179], 0
    ds_read_b128 v[164:167], v1 offset:15360
    s_waitcnt lgkmcnt(4)
    v_mfma_f32_16x16x32_bf16 v[124:127], v[168:171], v[180:183], 0
    v_mfma_f32_16x16x32_bf16 v[128:131], v[172:175], v[176:179], 0
    ds_read_b128 v[168:171], v1 offset:16384
    s_waitcnt lgkmcnt(4)
    v_mfma_f32_16x16x32_bf16 v[132:135], v[172:175], v[180:183], 0
    buffer_load_dwordx4 v[224:227], v1, s[4:7], s58 offen offset:2048 sc1
    v_mfma_f32_16x16x32_bf16 v[136:139], v[152:155], v[176:179], 0
    ds_read_b128 v[172:175], v1 offset:17408
    s_waitcnt lgkmcnt(4)
    v_mfma_f32_16x16x32_bf16 v[140:143], v[152:155], v[180:183], 0
    v_mfma_f32_16x16x32_bf16 v[144:147], v[156:159], v[176:179], 0
    ds_read_b128 v[152:155], v1 offset:18432
    s_waitcnt vmcnt(13) lgkmcnt(4)
    v_mfma_f32_16x16x32_bf16 v[148:151], v[156:159], v[180:183], 0
    buffer_load_dwordx4 v[228:231], v1, s[4:7], s59 offen offset:2048 sc1
    v_mfma_f32_16x16x32_bf16 v[40:43], v[160:163], v[184:187], v[40:43]
    ds_read_b128 v[156:159], v1 offset:19456
    s_waitcnt lgkmcnt(4)
    v_mfma_f32_16x16x32_bf16 v[44:47], v[160:163], v[188:191], v[44:47]
    buffer_load_dwordx4 v[232:235], v1, s[4:7], s58 offen offset:3072 sc1
    v_mfma_f32_16x16x32_bf16 v[48:51], v[164:167], v[184:187], v[48:51]
    ds_read_b128 v[160:163], v1 offset:20480
    s_waitcnt lgkmcnt(4)
    v_mfma_f32_16x16x32_bf16 v[52:55], v[164:167], v[188:191], v[52:55]
    v_mfma_f32_16x16x32_bf16 v[56:59], v[168:171], v[184:187], v[56:59]
    ds_read_b128 v[164:167], v1 offset:21504
    s_waitcnt lgkmcnt(4)
    v_mfma_f32_16x16x32_bf16 v[60:63], v[168:171], v[188:191], v[60:63]
    buffer_load_dwordx4 v[236:239], v1, s[4:7], s59 offen offset:3072 sc1
    v_mfma_f32_16x16x32_bf16 v[64:67], v[172:175], v[184:187], v[64:67]
    ds_read_b128 v[168:171], v1 offset:22528
    s_waitcnt lgkmcnt(4)
    v_mfma_f32_16x16x32_bf16 v[68:71], v[172:175], v[188:191], v[68:71]
    s_waitcnt vmcnt(12)
    v_pk_add_f32 v[10:11], v[10:11], v[12:13]
    v_mfma_f32_16x16x32_bf16 v[72:75], v[152:155], v[184:187], v[72:75]
    ds_read_b128 v[172:175], v1 offset:23552
    s_waitcnt lgkmcnt(4)
    v_mfma_f32_16x16x32_bf16 v[76:79], v[152:155], v[188:191], v[76:79]
    s_add_u32 s58, s58, 4096
    s_add_u32 s59, s59, 4096
    v_mfma_f32_16x16x32_bf16 v[80:83], v[156:159], v[184:187], v[80:83]
    ds_read_b128 v[152:155], v1 offset:24576
    s_waitcnt lgkmcnt(4)
    v_mfma_f32_16x16x32_bf16 v[84:87], v[156:159], v[188:191], v[84:87]
    buffer_load_dwordx4 v[240:243], v1, s[4:7], s58 offen offset:0 sc1
    v_mfma_f32_16x16x32_bf16 v[88:91], v[160:163], v[184:187], v[88:91]
    ds_read_b128 v[156:159], v1 offset:25600
    s_waitcnt lgkmcnt(4)
    v_mfma_f32_16x16x32_bf16 v[92:95], v[160:163], v[188:191], v[92:95]
    buffer_load_dwordx4 v[244:247], v1, s[4:7], s59 offen offset:0 sc1
    v_mfma_f32_16x16x32_bf16 v[96:99], v[164:167], v[184:187], v[96:99]
    ds_read_b128 v[160:163], v1 offset:26624
    s_waitcnt lgkmcnt(4)
    v_mfma_f32_16x16x32_bf16 v[100:103], v[164:167], v[188:191], v[100:103]
    v_pk_add_f32 v[14:15], v[14:15], v[16:17]
    v_mov_b32 v12, v10
    v_mfma_f32_16x16x32_bf16 v[104:107], v[168:171], v[184:187], v[104:107]
    ds_read_b128 v[164:167], v1 offset:27648
    s_waitcnt lgkmcnt(4)
    v_mfma_f32_16x16x32_bf16 v[108:111], v[168:171], v[188:191], v[108:111]
    buffer_load_dwordx4 v[248:251], v1, s[4:7], s58 offen offset:1024 sc1
    v_mfma_f32_16x16x32_bf16 v[112:115], v[172:175], v[184:187], v[112:115]
    ds_read_b128 v[168:171], v1 offset:28672
    s_waitcnt lgkmcnt(4)
    v_mfma_f32_16x16x32_bf16 v[116:119], v[172:175], v[188:191], v[116:119]
    v_mov_b32 v13, v11
    v_mov_b32 v16, v14
    v_mfma_f32_16x16x32_bf16 v[120:123], v[152:155], v[184:187], v[120:123]
    ds_read_b128 v[172:175], v1 offset:29696
    s_waitcnt lgkmcnt(4)
    v_mfma_f32_16x16x32_bf16 v[124:127], v[152:155], v[188:191], v[124:127]
    buffer_load_dwordx4 v[252:255], v1, s[4:7], s59 offen offset:1024 sc1
    v_mfma_f32_16x16x32_bf16 v[128:131], v[156:159], v[184:187], v[128:131]
    ds_read_b128 v[152:155], v1 offset:30720
    s_waitcnt lgkmcnt(4)
    v_mfma_f32_16x16x32_bf16 v[132:135], v[156:159], v[188:191], v[132:135]
    v_mov_b32 v17, v15
    v_permlane16_swap_b32 v10, v12
    v_mfma_f32_16x16x32_bf16 v[136:139], v[160:163], v[184:187], v[136:139]
    ds_read_b128 v[156:159], v1 offset:31744
    s_waitcnt lgkmcnt(4)
    v_mfma_f32_16x16x32_bf16 v[140:143], v[160:163], v[188:191], v[140:143]
    buffer_load_dwordx4 v[176:179], v1, s[4:7], s58 offen offset:2048 sc1
    v_mfma_f32_16x16x32_bf16 v[144:147], v[164:167], v[184:187], v[144:147]
    ds_read_b128 v[160:163], v1 offset:32768
    s_waitcnt vmcnt(15) lgkmcnt(4)
    v_mfma_f32_16x16x32_bf16 v[148:151], v[164:167], v[188:191], v[148:151]
    s_barrier
    v_mfma_f32_16x16x32_bf16 v[40:43], v[168:171], v[192:195], v[40:43]
    ds_read_b128 v[164:167], v1 offset:33792
    s_waitcnt lgkmcnt(4)
    v_mfma_f32_16x16x32_bf16 v[44:47], v[168:171], v[196:199], v[44:47]
    buffer_load_dwordx4 v[180:183], v1, s[4:7], s59 offen offset:2048 sc1
    v_mfma_f32_16x16x32_bf16 v[48:51], v[172:175], v[192:195], v[48:51]
    ds_read_b128 v[168:171], v1 offset:34816
    s_waitcnt lgkmcnt(4)
    v_mfma_f32_16x16x32_bf16 v[52:55], v[172:175], v[196:199], v[52:55]
    buffer_load_dwordx4 v[184:187], v1, s[4:7], s58 offen offset:3072 sc1
    v_mfma_f32_16x16x32_bf16 v[56:59], v[152:155], v[192:195], v[56:59]
    ds_read_b128 v[172:175], v1 offset:35840
    s_waitcnt lgkmcnt(4)
    v_mfma_f32_16x16x32_bf16 v[60:63], v[152:155], v[196:199], v[60:63]
    s_add_u32 m0, s42, 0
    s_add_u32 s43, s95, 147456
    v_mfma_f32_16x16x32_bf16 v[64:67], v[156:159], v[192:195], v[64:67]
    ds_read_b128 v[152:155], v1 offset:36864
    s_waitcnt lgkmcnt(4)
    v_mfma_f32_16x16x32_bf16 v[68:71], v[156:159], v[196:199], v[68:71]
    buffer_load_dwordx4 v2, s[4:7], s43 offen sc1 lds
    v_mfma_f32_16x16x32_bf16 v[72:75], v[160:163], v[192:195], v[72:75]
    ds_read_b128 v[156:159], v1 offset:37888
    s_waitcnt lgkmcnt(4)
    v_mfma_f32_16x16x32_bf16 v[76:79], v[160:163], v[196:199], v[76:79]
    v_mfma_f32_16x16x32_bf16 v[80:83], v[164:167], v[192:195], v[80:83]
    ds_read_b128 v[160:163], v1 offset:38912
    s_waitcnt lgkmcnt(4)
    v_mfma_f32_16x16x32_bf16 v[84:87], v[164:167], v[196:199], v[84:87]
    buffer_load_dwordx4 v2, s[4:7], s43 offen offset:1024 sc1 lds
    v_mfma_f32_16x16x32_bf16 v[88:91], v[168:171], v[192:195], v[88:91]
    ds_read_b128 v[164:167], v1 offset:39936
    s_waitcnt lgkmcnt(4)
    v_mfma_f32_16x16x32_bf16 v[92:95], v[168:171], v[196:199], v[92:95]
    s_add_u32 m0, s42, 8192
    s_add_u32 s43, s95, 155648
    v_mfma_f32_16x16x32_bf16 v[96:99], v[172:175], v[192:195], v[96:99]
    ds_read_b128 v[168:171], v1 offset:40960
    s_waitcnt lgkmcnt(4)
    v_mfma_f32_16x16x32_bf16 v[100:103], v[172:175], v[196:199], v[100:103]
    buffer_load_dwordx4 v2, s[4:7], s43 offen sc1 lds
    v_mfma_f32_16x16x32_bf16 v[104:107], v[152:155], v[192:195], v[104:107]
    ds_read_b128 v[172:175], v1 offset:41984
    s_waitcnt lgkmcnt(4)
    v_mfma_f32_16x16x32_bf16 v[108:111], v[152:155], v[196:199], v[108:111]
    v_mfma_f32_16x16x32_bf16 v[112:115], v[156:159], v[192:195], v[112:115]
    ds_read_b128 v[152:155], v1 offset:43008
    s_waitcnt lgkmcnt(4)
    v_mfma_f32_16x16x32_bf16 v[116:119], v[156:159], v[196:199], v[116:119]
    buffer_load_dwordx4 v2, s[4:7], s43 offen offset:1024 sc1 lds
    v_mfma_f32_16x16x32_bf16 v[120:123], v[160:163], v[192:195], v[120:123]
    ds_read_b128 v[156:159], v1 offset:44032
    s_waitcnt lgkmcnt(4)
    v_mfma_f32_16x16x32_bf16 v[124:127], v[160:163], v[196:199], v[124:127]
    buffer_load_dwordx4 v[188:191], v1, s[4:7], s59 offen offset:3072 sc1
    v_mfma_f32_16x16x32_bf16 v[128:131], v[164:167], v[192:195], v[128:131]
    ds_read_b128 v[160:163], v1 offset:45056
    s_waitcnt lgkmcnt(4)
    v_mfma_f32_16x16x32_bf16 v[132:135], v[164:167], v[196:199], v[132:135]
    s_add_u32 m0, s42, 16384
    s_add_u32 s43, s95, 163840
    v_mfma_f32_16x16x32_bf16 v[136:139], v[168:171], v[192:195], v[136:139]
    ds_read_b128 v[164:167], v1 offset:46080
    s_waitcnt lgkmcnt(4)
    v_mfma_f32_16x16x32_bf16 v[140:143], v[168:171], v[196:199], v[140:143]
    buffer_load_dwordx4 v2, s[4:7], s43 offen sc1 lds
    v_mfma_f32_16x16x32_bf16 v[144:147], v[172:175], v[192:195], v[144:147]
    ds_read_b128 v[168:171], v1 offset:47104
    s_waitcnt vmcnt(21) lgkmcnt(4)
    v_mfma_f32_16x16x32_bf16 v[148:151], v[172:175], v[196:199], v[148:151]
    v_mfma_f32_16x16x32_bf16 v[40:43], v[152:155], v[200:203], v[40:43]
    ds_read_b128 v[172:175], v1 offset:48128
    s_waitcnt lgkmcnt(4)
    v_mfma_f32_16x16x32_bf16 v[44:47], v[152:155], v[204:207], v[44:47]
    buffer_load_dwordx4 v2, s[4:7], s43 offen offset:1024 sc1 lds
    v_mfma_f32_16x16x32_bf16 v[48:51], v[156:159], v[200:203], v[48:51]
    ds_read_b128 v[152:155], v1 offset:49152
    s_waitcnt lgkmcnt(4)
    v_mfma_f32_16x16x32_bf16 v[52:55], v[156:159], v[204:207], v[52:55]
    s_add_u32 s58, s58, 4096
    s_add_u32 s59, s59, 4096
    v_mfma_f32_16x16x32_bf16 v[56:59], v[160:163], v[200:203], v[56:59]
    ds_read_b128 v[156:159], v1 offset:50176
    s_waitcnt lgkmcnt(4)
    v_mfma_f32_16x16x32_bf16 v[60:63], v[160:163], v[204:207], v[60:63]
    buffer_load_dwordx4 v[192:195], v1, s[4:7], s58 offen offset:0 sc1
    v_mfma_f32_16x16x32_bf16 v[64:67], v[164:167], v[200:203], v[64:67]
    ds_read_b128 v[160:163], v1 offset:51200
    s_waitcnt lgkmcnt(4)
    v_mfma_f32_16x16x32_bf16 v[68:71], v[164:167], v[204:207], v[68:71]
    v_permlane16_swap_b32 v11, v13
    v_permlane16_swap_b32 v14, v16
    v_mfma_f32_16x16x32_bf16 v[72:75], v[168:171], v[200:203], v[72:75]
    ds_read_b128 v[164:167], v1 offset:52224
    s_waitcnt lgkmcnt(4)
    v_mfma_f32_16x16x32_bf16 v[76:79], v[168:171], v[204:207], v[76:79]
    buffer_load_dwordx4 v[196:199], v1, s[4:7], s59 offen offset:0 sc1
    v_mfma_f32_16x16x32_bf16 v[80:83], v[172:175], v[200:203], v[80:83]
    ds_read_b128 v[168:171], v1 offset:53248
    s_waitcnt lgkmcnt(4)
    v_mfma_f32_16x16x32_bf16 v[84:87], v[172:175], v[204:207], v[84:87]
    v_permlane16_swap_b32 v15, v17
    v_add_f32 v10, v10, v12
    v_mfma_f32_16x16x32_bf16 v[88:91], v[152:155], v[200:203], v[88:91]
    ds_read_b128 v[172:175], v1 offset:54272
    s_waitcnt lgkmcnt(4)
    v_mfma_f32_16x16x32_bf16 v[92:95], v[152:155], v[204:207], v[92:95]
    v_add_f32 v11, v11, v13
    v_add_f32 v14, v14, v16
    v_mfma_f32_16x16x32_bf16 v[96:99], v[156:159], v[200:203], v[96:99]
    ds_read_b128 v[152:155], v1 offset:55296
    s_waitcnt lgkmcnt(4)
    v_mfma_f32_16x16x32_bf16 v[100:103], v[156:159], v[204:207], v[100:103]
    v_add_f32 v15, v15, v17
    v_mov_b32 v12, v10
    v_mfma_f32_16x16x32_bf16 v[104:107], v[160:163], v[200:203], v[104:107]
    ds_read_b128 v[156:159], v1 offset:56320
    s_waitcnt lgkmcnt(4)
    v_mfma_f32_16x16x32_bf16 v[108:111], v[160:163], v[204:207], v[108:111]
    v_mov_b32 v13, v11
    v_mov_b32 v16, v14
    v_mfma_f32_16x16x32_bf16 v[112:115], v[164:167], v[200:203], v[112:115]
    ds_read_b128 v[160:163], v1 offset:57344
    s_waitcnt lgkmcnt(4)
    v_mfma_f32_16x16x32_bf16 v[116:119], v[164:167], v[204:207], v[116:119]
    v_mov_b32 v17, v15
    v_permlane32_swap_b32 v10, v12
    v_mfma_f32_16x16x32_bf16 v[120:123], v[168:171], v[200:203], v[120:123]
    ds_read_b128 v[164:167], v1 offset:58368
    s_waitcnt lgkmcnt(4)
    v_mfma_f32_16x16x32_bf16 v[124:127], v[168:171], v[204:207], v[124:127]
    v_permlane32_swap_b32 v11, v13
    v_permlane32_swap_b32 v14, v16
    v_mfma_f32_16x16x32_bf16 v[128:131], v[172:175], v[200:203], v[128:131]
    ds_read_b128 v[168:171], v1 offset:59392
    s_waitcnt lgkmcnt(4)
    v_mfma_f32_16x16x32_bf16 v[132:135], v[172:175], v[204:207], v[132:135]
    v_permlane32_swap_b32 v15, v17
    v_add_f32 v10, v10, v12
    v_mfma_f32_16x16x32_bf16 v[136:139], v[152:155], v[200:203], v[136:139]
    ds_read_b128 v[172:175], v1 offset:60416
    s_waitcnt lgkmcnt(4)
    v_mfma_f32_16x16x32_bf16 v[140:143], v[152:155], v[204:207], v[140:143]
    v_add_f32 v11, v11, v13
    v_add_f32 v14, v14, v16
    v_mfma_f32_16x16x32_bf16 v[144:147], v[156:159], v[200:203], v[144:147]
    ds_read_b128 v[152:155], v1 offset:61440
    s_waitcnt vmcnt(22) lgkmcnt(4)
    v_mfma_f32_16x16x32_bf16 v[148:151], v[156:159], v[204:207], v[148:151]
    s_barrier
    v_mfma_f32_16x16x32_bf16 v[40:43], v[160:163], v[208:211], v[40:43]
    ds_read_b128 v[156:159], v1 offset:62464
    s_waitcnt lgkmcnt(4)
    v_mfma_f32_16x16x32_bf16 v[44:47], v[160:163], v[212:215], v[44:47]
    buffer_load_dwordx4 v[200:203], v1, s[4:7], s58 offen offset:1024 sc1
    v_mfma_f32_16x16x32_bf16 v[48:51], v[164:167], v[208:211], v[48:51]
    ds_read_b128 v[160:163], v1 offset:63488
    s_waitcnt lgkmcnt(4)
    v_mfma_f32_16x16x32_bf16 v[52:55], v[164:167], v[212:215], v[52:55]
    buffer_load_dwordx4 v[204:207], v1, s[4:7], s59 offen offset:1024 sc1
    v_mfma_f32_16x16x32_bf16 v[56:59], v[168:171], v[208:211], v[56:59]
    ds_read_b128 v[164:167], v1 offset:64512
    s_waitcnt lgkmcnt(4)
    v_mfma_f32_16x16x32_bf16 v[60:63], v[168:171], v[212:215], v[60:63]
    s_add_u32 m0, s42, 24576
    s_add_u32 s43, s95, 172032
    v_mfma_f32_16x16x32_bf16 v[64:67], v[172:175], v[208:211], v[64:67]
    ds_read_b128 v[168:171], v3 offset:0
    s_waitcnt lgkmcnt(4)
    v_mfma_f32_16x16x32_bf16 v[68:71], v[172:175], v[212:215], v[68:71]
    buffer_load_dwordx4 v2, s[4:7], s43 offen sc1 lds
    v_mfma_f32_16x16x32_bf16 v[72:75], v[152:155], v[208:211], v[72:75]
    ds_read_b128 v[172:175], v3 offset:1024
    s_waitcnt lgkmcnt(4)
    v_mfma_f32_16x16x32_bf16 v[76:79], v[152:155], v[212:215], v[76:79]
    v_mfma_f32_16x16x32_bf16 v[80:83], v[156:159], v[208:211], v[80:83]
    ds_read_b128 v[152:155], v3 offset:2048
    s_waitcnt lgkmcnt(4)
    v_mfma_f32_16x16x32_bf16 v[84:87], v[156:159], v[212:215], v[84:87]
    buffer_load_dwordx4 v2, s[4:7], s43 offen offset:1024 sc1 lds
    v_mfma_f32_16x16x32_bf16 v[88:91], v[160:163], v[208:211], v[88:91]
    ds_read_b128 v[156:159], v3 offset:3072
    s_waitcnt lgkmcnt(4)
    v_mfma_f32_16x16x32_bf16 v[92:95], v[160:163], v[212:215], v[92:95]
    s_add_u32 m0, s42, 32768
    s_add_u32 s43, s95, 180224
    v_mfma_f32_16x16x32_bf16 v[96:99], v[164:167], v[208:211], v[96:99]
    ds_read_b128 v[160:163], v3 offset:4096
    s_waitcnt lgkmcnt(4)
    v_mfma_f32_16x16x32_bf16 v[100:103], v[164:167], v[212:215], v[100:103]
    buffer_load_dwordx4 v2, s[4:7], s43 offen sc1 lds
    v_mfma_f32_16x16x32_bf16 v[104:107], v[168:171], v[208:211], v[104:107]
    ds_read_b128 v[164:167], v3 offset:5120
    s_waitcnt lgkmcnt(4)
    v_mfma_f32_16x16x32_bf16 v[108:111], v[168:171], v[212:215], v[108:111]
    v_mfma_f32_16x16x32_bf16 v[112:115], v[172:175], v[208:211], v[112:115]
    ds_read_b128 v[168:171], v3 offset:6144
    s_waitcnt lgkmcnt(4)
    v_mfma_f32_16x16x32_bf16 v[116:119], v[172:175], v[212:215], v[116:119]
    buffer_load_dwordx4 v2, s[4:7], s43 offen offset:1024 sc1 lds
    v_mfma_f32_16x16x32_bf16 v[120:123], v[152:155], v[208:211], v[120:123]
    ds_read_b128 v[172:175], v3 offset:7168
    s_waitcnt lgkmcnt(4)
    v_mfma_f32_16x16x32_bf16 v[124:127], v[152:155], v[212:215], v[124:127]
    s_add_u32 m0, s42, 40960
    s_add_u32 s43, s95, 188416
    v_mfma_f32_16x16x32_bf16 v[128:131], v[156:159], v[208:211], v[128:131]
    ds_read_b128 v[152:155], v3 offset:8192
    s_waitcnt lgkmcnt(4)
    v_mfma_f32_16x16x32_bf16 v[132:135], v[156:159], v[212:215], v[132:135]
    buffer_load_dwordx4 v2, s[4:7], s43 offen sc1 lds
    v_mfma_f32_16x16x32_bf16 v[136:139], v[160:163], v[208:211], v[136:139]
    ds_read_b128 v[156:159], v3 offset:9216
    s_waitcnt lgkmcnt(4)
    v_mfma_f32_16x16x32_bf16 v[140:143], v[160:163], v[212:215], v[140:143]
    buffer_load_dwordx4 v2, s[4:7], s43 offen offset:1024 sc1 lds
    v_mfma_f32_16x16x32_bf16 v[144:147], v[164:167], v[208:211], v[144:147]
    ds_read_b128 v[160:163], v3 offset:10240
    s_waitcnt vmcnt(28) lgkmcnt(4)
    v_mfma_f32_16x16x32_bf16 v[148:151], v[164:167], v[212:215], v[148:151]
    s_add_u32 m0, s42, 49152
    s_add_u32 s43, s95, 196608
    v_mfma_f32_16x16x32_bf16 v[40:43], v[168:171], v[216:219], v[40:43]
    ds_read_b128 v[164:167], v3 offset:11264
    s_waitcnt lgkmcnt(4)
    v_mfma_f32_16x16x32_bf16 v[44:47], v[168:171], v[220:223], v[44:47]
    buffer_load_dwordx4 v2, s[4:7], s43 offen sc1 lds
    v_mfma_f32_16x16x32_bf16 v[48:51], v[172:175], v[216:219], v[48:51]
    ds_read_b128 v[168:171], v3 offset:12288
    s_waitcnt lgkmcnt(4)
    v_mfma_f32_16x16x32_bf16 v[52:55], v[172:175], v[220:223], v[52:55]
    v_mfma_f32_16x16x32_bf16 v[56:59], v[152:155], v[216:219], v[56:59]
    ds_read_b128 v[172:175], v3 offset:13312
    s_waitcnt lgkmcnt(4)
    v_mfma_f32_16x16x32_bf16 v[60:63], v[152:155], v[220:223], v[60:63]
    buffer_load_dwordx4 v2, s[4:7], s43 offen offset:1024 sc1 lds
    v_mfma_f32_16x16x32_bf16 v[64:67], v[156:159], v[216:219], v[64:67]
    ds_read_b128 v[152:155], v3 offset:14336
    s_waitcnt lgkmcnt(4)
    v_mfma_f32_16x16x32_bf16 v[68:71], v[156:159], v[220:223], v[68:71]
    v_add_f32 v15, v15, v17
    v_mul_f32 v10, 0xbacccccd, v10
    v_mfma_f32_16x16x32_bf16 v[72:75], v[160:163], v[216:219], v[72:75]
    ds_read_b128 v[156:159], v3 offset:15360
    s_waitcnt lgkmcnt(4)
    v_mfma_f32_16x16x32_bf16 v[76:79], v[160:163], v[220:223], v[76:79]
    buffer_load_dwordx4 v[208:211], v1, s[4:7], s58 offen offset:2048 sc1
    v_mfma_f32_16x16x32_bf16 v[80:83], v[164:167], v[216:219], v[80:83]
    ds_read_b128 v[160:163], v3 offset:16384
    s_waitcnt lgkmcnt(4)
    v_mfma_f32_16x16x32_bf16 v[84:87], v[164:167], v[220:223], v[84:87]
    v_mul_f32 v11, 0x3acccccd, v11
    v_mul_f32 v14, 0xbacccccd, v14
    v_mfma_f32_16x16x32_bf16 v[88:91], v[168:171], v[216:219], v[88:91]
    ds_read_b128 v[164:167], v3 offset:17408
    s_waitcnt lgkmcnt(4)
    v_mfma_f32_16x16x32_bf16 v[92:95], v[168:171], v[220:223], v[92:95]
    buffer_load_dwordx4 v[212:215], v1, s[4:7], s59 offen offset:2048 sc1
    v_mfma_f32_16x16x32_bf16 v[96:99], v[172:175], v[216:219], v[96:99]
    ds_read_b128 v[168:171], v3 offset:18432
    s_waitcnt lgkmcnt(4)
    v_mfma_f32_16x16x32_bf16 v[100:103], v[172:175], v[220:223], v[100:103]
    v_mul_f32 v15, 0x3acccccd, v15
    v_fma_f32 v11, -v10, v10, v11
    v_mfma_f32_16x16x32_bf16 v[104:107], v[152:155], v[216:219], v[104:107]
    ds_read_b128 v[172:175], v3 offset:19456
    s_waitcnt lgkmcnt(4)
    v_mfma_f32_16x16x32_bf16 v[108:111], v[152:155], v[220:223], v[108:111]
    v_fma_f32 v15, -v14, v14, v15
    v_max_f32 v11, 0, v11
    v_mfma_f32_16x16x32_bf16 v[112:115], v[156:159], v[216:219], v[112:115]
    ds_read_b128 v[152:155], v3 offset:20480
    s_waitcnt lgkmcnt(4)
    v_mfma_f32_16x16x32_bf16 v[116:119], v[156:159], v[220:223], v[116:119]
    v_max_f32 v15, 0, v15
    v_add_f32 v11, 0x3727c5ac, v11
    v_mfma_f32_16x16x32_bf16 v[120:123], v[160:163], v[216:219], v[120:123]
    ds_read_b128 v[156:159], v3 offset:21504
    s_waitcnt lgkmcnt(4)
    v_mfma_f32_16x16x32_bf16 v[124:127], v[160:163], v[220:223], v[124:127]
    v_add_f32 v15, 0x3727c5ac, v15
    v_mfma_f32_16x16x32_bf16 v[128:131], v[164:167], v[216:219], v[128:131]
    ds_read_b128 v[160:163], v3 offset:22528
    s_waitcnt lgkmcnt(4)
    v_mfma_f32_16x16x32_bf16 v[132:135], v[164:167], v[220:223], v[132:135]
    v_rsq_f32 v11, v11
    v_mfma_f32_16x16x32_bf16 v[136:139], v[168:171], v[216:219], v[136:139]
    ds_read_b128 v[164:167], v3 offset:23552
    s_waitcnt lgkmcnt(4)
    v_mfma_f32_16x16x32_bf16 v[140:143], v[168:171], v[220:223], v[140:143]
    v_rsq_f32 v15, v15
    v_mfma_f32_16x16x32_bf16 v[144:147], v[172:175], v[216:219], v[144:147]
    ds_read_b128 v[168:171], v3 offset:24576
    s_waitcnt vmcnt(30) lgkmcnt(4)
    v_mfma_f32_16x16x32_bf16 v[148:151], v[172:175], v[220:223], v[148:151]
    s_barrier
    v_mfma_f32_16x16x32_bf16 v[40:43], v[152:155], v[224:227], v[40:43]
    ds_read_b128 v[172:175], v3 offset:25600
    s_waitcnt lgkmcnt(4)
    v_mfma_f32_16x16x32_bf16 v[44:47], v[152:155], v[228:231], v[44:47]
    buffer_load_dwordx4 v[216:219], v1, s[4:7], s58 offen offset:3072 sc1
    v_mfma_f32_16x16x32_bf16 v[48:51], v[156:159], v[224:227], v[48:51]
    ds_read_b128 v[152:155], v3 offset:26624
    s_waitcnt lgkmcnt(4)
    v_mfma_f32_16x16x32_bf16 v[52:55], v[156:159], v[228:231], v[52:55]
    buffer_load_dwordx4 v[220:223], v1, s[4:7], s59 offen offset:3072 sc1
    v_mfma_f32_16x16x32_bf16 v[56:59], v[160:163], v[224:227], v[56:59]
    ds_read_b128 v[156:159], v3 offset:27648
    s_waitcnt lgkmcnt(4)
    v_mfma_f32_16x16x32_bf16 v[60:63], v[160:163], v[228:231], v[60:63]
    s_add_u32 m0, s42, 57344
    s_add_u32 s43, s95, 204800
    v_mfma_f32_16x16x32_bf16 v[64:67], v[164:167], v[224:227], v[64:67]
    ds_read_b128 v[160:163], v3 offset:28672
    s_waitcnt lgkmcnt(4)
    v_mfma_f32_16x16x32_bf16 v[68:71], v[164:167], v[228:231], v[68:71]
    buffer_load_dwordx4 v2, s[4:7], s43 offen sc1 lds
    v_mfma_f32_16x16x32_bf16 v[72:75], v[168:171], v[224:227], v[72:75]
    ds_read_b128 v[164:167], v3 offset:29696
    s_waitcnt lgkmcnt(4)
    v_mfma_f32_16x16x32_bf16 v[76:79], v[168:171], v[228:231], v[76:79]
    v_mfma_f32_16x16x32_bf16 v[80:83], v[172:175], v[224:227], v[80:83]
    ds_read_b128 v[168:171], v3 offset:30720
    s_waitcnt lgkmcnt(4)
    v_mfma_f32_16x16x32_bf16 v[84:87], v[172:175], v[228:231], v[84:87]
    buffer_load_dwordx4 v2, s[4:7], s43 offen offset:1024 sc1 lds
    v_mfma_f32_16x16x32_bf16 v[88:91], v[152:155], v[224:227], v[88:91]
    ds_read_b128 v[172:175], v3 offset:31744
    s_waitcnt lgkmcnt(4)
    v_mfma_f32_16x16x32_bf16 v[92:95], v[152:155], v[228:231], v[92:95]
    s_add_u32 m0, s42, 65536
    s_add_u32 s43, s95, 212992
    v_mfma_f32_16x16x32_bf16 v[96:99], v[156:159], v[224:227], v[96:99]
    ds_read_b128 v[152:155], v3 offset:32768
    s_waitcnt lgkmcnt(4)
    v_mfma_f32_16x16x32_bf16 v[100:103], v[156:159], v[228:231], v[100:103]
    buffer_load_dwordx4 v2, s[4:7], s43 offen sc1 lds
    v_mfma_f32_16x16x32_bf16 v[104:107], v[160:163], v[224:227], v[104:107]
    ds_read_b128 v[156:159], v3 offset:33792
    s_waitcnt lgkmcnt(4)
    v_mfma_f32_16x16x32_bf16 v[108:111], v[160:163], v[228:231], v[108:111]
    v_mfma_f32_16x16x32_bf16 v[112:115], v[164:167], v[224:227], v[112:115]
    ds_read_b128 v[160:163], v3 offset:34816
    s_waitcnt lgkmcnt(4)
    v_mfma_f32_16x16x32_bf16 v[116:119], v[164:167], v[228:231], v[116:119]
    buffer_load_dwordx4 v2, s[4:7], s43 offen offset:1024 sc1 lds
    v_mfma_f32_16x16x32_bf16 v[120:123], v[168:171], v[224:227], v[120:123]
    ds_read_b128 v[164:167], v3 offset:35840
    s_waitcnt lgkmcnt(4)
    v_mfma_f32_16x16x32_bf16 v[124:127], v[168:171], v[228:231], v[124:127]
    s_add_u32 m0, s42, 73728
    s_add_u32 s43, s95, 221184
    v_mfma_f32_16x16x32_bf16 v[128:131], v[172:175], v[224:227], v[128:131]
    ds_read_b128 v[168:171], v3 offset:36864
    s_waitcnt lgkmcnt(4)
    v_mfma_f32_16x16x32_bf16 v[132:135], v[172:175], v[228:231], v[132:135]
    buffer_load_dwordx4 v2, s[4:7], s43 offen sc1 lds
    v_mfma_f32_16x16x32_bf16 v[136:139], v[152:155], v[224:227], v[136:139]
    ds_read_b128 v[172:175], v3 offset:37888
    s_waitcnt lgkmcnt(4)
    v_mfma_f32_16x16x32_bf16 v[140:143], v[152:155], v[228:231], v[140:143]
    buffer_load_dwordx4 v2, s[4:7], s43 offen offset:1024 sc1 lds
    v_mfma_f32_16x16x32_bf16 v[144:147], v[156:159], v[224:227], v[144:147]
    ds_read_b128 v[152:155], v3 offset:38912
    s_waitcnt vmcnt(36) lgkmcnt(4)
    v_mfma_f32_16x16x32_bf16 v[148:151], v[156:159], v[228:231], v[148:151]
    v_mul_f32 v11, v11, v11
    v_mul_f32 v15, v15, v15
    v_mfma_f32_16x16x32_bf16 v[40:43], v[160:163], v[232:235], v[40:43]
    ds_read_b128 v[156:159], v3 offset:39936
    s_waitcnt lgkmcnt(4)
    v_mfma_f32_16x16x32_bf16 v[44:47], v[160:163], v[236:239], v[44:47]
    s_add_u32 s58, s58, 4096
    s_add_u32 s59, s59, 4096
    v_mfma_f32_16x16x32_bf16 v[48:51], v[164:167], v[232:235], v[48:51]
    ds_read_b128 v[160:163], v3 offset:40960
    s_waitcnt lgkmcnt(4)
    v_mfma_f32_16x16x32_bf16 v[52:55], v[164:167], v[236:239], v[52:55]
    buffer_load_dwordx4 v[224:227], v1, s[4:7], s58 offen offset:0 sc1
    v_mfma_f32_16x16x32_bf16 v[56:59], v[168:171], v[232:235], v[56:59]
    ds_read_b128 v[164:167], v3 offset:41984
    s_waitcnt lgkmcnt(4)
    v_mfma_f32_16x16x32_bf16 v[60:63], v[168:171], v[236:239], v[60:63]
    buffer_load_dwordx4 v[228:231], v1, s[4:7], s59 offen offset:0 sc1
    v_mfma_f32_16x16x32_bf16 v[64:67], v[172:175], v[232:235], v[64:67]
    ds_read_b128 v[168:171], v3 offset:43008
    s_waitcnt lgkmcnt(4)
    v_mfma_f32_16x16x32_bf16 v[68:71], v[172:175], v[236:239], v[68:71]
    v_and_b32 v12, 48, v0
    v_add_u32 v12, 161280, v12
    v_mfma_f32_16x16x32_bf16 v[72:75], v[152:155], v[232:235], v[72:75]
    ds_read_b128 v[172:175], v3 offset:44032
    s_waitcnt lgkmcnt(4)
    v_mfma_f32_16x16x32_bf16 v[76:79], v[152:155], v[236:239], v[76:79]
    s_mul_i32 s52, s41, 7077888
    s_mul_i32 s53, s72, 55296
    v_mfma_f32_16x16x32_bf16 v[80:83], v[156:159], v[232:235], v[80:83]
    ds_read_b128 v[152:155], v3 offset:45056
    s_waitcnt lgkmcnt(4)
    v_mfma_f32_16x16x32_bf16 v[84:87], v[156:159], v[236:239], v[84:87]
    s_add_u32 s52, s52, s53
    s_add_u32 s52, s52, 29220864
    v_mfma_f32_16x16x32_bf16 v[88:91], v[160:163], v[232:235], v[88:91]
    ds_read_b128 v[156:159], v3 offset:46080
    s_waitcnt lgkmcnt(4)
    v_mfma_f32_16x16x32_bf16 v[92:95], v[160:163], v[236:239], v[92:95]
    s_mul_i32 s53, s17, 3072
    s_add_u32 s96, s52, s53
    v_mfma_f32_16x16x32_bf16 v[96:99], v[164:167], v[232:235], v[96:99]
    ds_read_b128 v[160:163], v3 offset:47104
    s_waitcnt lgkmcnt(4)
    v_mfma_f32_16x16x32_bf16 v[100:103], v[164:167], v[236:239], v[100:103]
    s_add_u32 s97, s96, 55296
    s_or_b32 s54, s96, s101
    v_mfma_f32_16x16x32_bf16 v[104:107], v[168:171], v[232:235], v[104:107]
    ds_read_b128 v[164:167], v3 offset:48128
    s_waitcnt lgkmcnt(4)
    v_mfma_f32_16x16x32_bf16 v[108:111], v[168:171], v[236:239], v[108:111]
    s_or_b32 s55, s97, s101
    s_lshl_b32 s53, s19, 10
    v_mfma_f32_16x16x32_bf16 v[112:115], v[172:175], v[232:235], v[112:115]
    ds_read_b128 v[168:171], v3 offset:49152
    s_waitcnt lgkmcnt(4)
    v_mfma_f32_16x16x32_bf16 v[116:119], v[172:175], v[236:239], v[116:119]
    s_add_u32 s52, s52, s53
    s_lshl_b32 s53, s40, 9
    v_mfma_f32_16x16x32_bf16 v[120:123], v[152:155], v[232:235], v[120:123]
    ds_read_b128 v[172:175], v3 offset:50176
    s_waitcnt lgkmcnt(4)
    v_mfma_f32_16x16x32_bf16 v[124:127], v[152:155], v[236:239], v[124:127]
    s_add_u32 s52, s52, s53
    s_add_u32 s98, s52, 47104
    v_mfma_f32_16x16x32_bf16 v[128:131], v[156:159], v[232:235], v[128:131]
    ds_read_b128 v[152:155], v3 offset:51200
    s_waitcnt lgkmcnt(4)
    v_mfma_f32_16x16x32_bf16 v[132:135], v[156:159], v[236:239], v[132:135]
    v_and_b32 v13, 15, v0
    v_lshrrev_b32 v16, 5, v0
    v_mfma_f32_16x16x32_bf16 v[136:139], v[160:163], v[232:235], v[136:139]
    ds_read_b128 v[156:159], v3 offset:52224
    s_waitcnt lgkmcnt(4)
    v_mfma_f32_16x16x32_bf16 v[140:143], v[160:163], v[236:239], v[140:143]
    v_lshl_add_u32 v13, v16, 4, v13
    v_lshlrev_b32 v13, 4, v13
    v_mfma_f32_16x16x32_bf16 v[144:147], v[164:167], v[232:235], v[144:147]
    ds_read_b128 v[160:163], v3 offset:53248
    s_waitcnt vmcnt(36) lgkmcnt(4)
    v_mfma_f32_16x16x32_bf16 v[148:151], v[164:167], v[236:239], v[148:151]
    s_waitcnt vmcnt(29)
    s_barrier
    v_mfma_f32_16x16x32_bf16 v[40:43], v[168:171], v[240:243], v[40:43]
    ds_read_b128 v[164:167], v3 offset:54272
    s_waitcnt lgkmcnt(4)
    v_mfma_f32_16x16x32_bf16 v[44:47], v[168:171], v[244:247], v[44:47]
    buffer_load_dwordx4 v[232:235], v1, s[4:7], s58 offen offset:1024 sc1
    v_mfma_f32_16x16x32_bf16 v[48:51], v[172:175], v[240:243], v[48:51]
    ds_read_b128 v[168:171], v3 offset:55296
    s_waitcnt lgkmcnt(4)
    v_mfma_f32_16x16x32_bf16 v[52:55], v[172:175], v[244:247], v[52:55]
    buffer_load_dwordx4 v[236:239], v1, s[4:7], s59 offen offset:1024 sc1
    v_mfma_f32_16x16x32_bf16 v[56:59], v[152:155], v[240:243], v[56:59]
    ds_read_b128 v[172:175], v3 offset:56320
    s_waitcnt lgkmcnt(4)
    v_mfma_f32_16x16x32_bf16 v[60:63], v[152:155], v[244:247], v[60:63]
    s_add_u32 m0, s42, 81920
    s_add_u32 s43, s95, 229376
    v_mfma_f32_16x16x32_bf16 v[64:67], v[156:159], v[240:243], v[64:67]
    ds_read_b128 v[152:155], v3 offset:57344
    s_waitcnt lgkmcnt(4)
    v_mfma_f32_16x16x32_bf16 v[68:71], v[156:159], v[244:247], v[68:71]
    buffer_load_dwordx4 v2, s[4:7], s43 offen sc1 lds
    v_mfma_f32_16x16x32_bf16 v[72:75], v[160:163], v[240:243], v[72:75]
    ds_read_b128 v[156:159], v3 offset:58368
    s_waitcnt lgkmcnt(4)
    v_mfma_f32_16x16x32_bf16 v[76:79], v[160:163], v[244:247], v[76:79]
    v_mfma_f32_16x16x32_bf16 v[80:83], v[164:167], v[240:243], v[80:83]
    ds_read_b128 v[160:163], v3 offset:59392
    s_waitcnt lgkmcnt(4)
    v_mfma_f32_16x16x32_bf16 v[84:87], v[164:167], v[244:247], v[84:87]
    buffer_load_dwordx4 v2, s[4:7], s43 offen offset:1024 sc1 lds
    v_mfma_f32_16x16x32_bf16 v[88:91], v[168:171], v[240:243], v[88:91]
    ds_read_b128 v[164:167], v3 offset:60416
    s_waitcnt lgkmcnt(4)
    v_mfma_f32_16x16x32_bf16 v[92:95], v[168:171], v[244:247], v[92:95]
    s_add_u32 m0, s42, 90112
    s_add_u32 s43, s95, 237568
    v_mfma_f32_16x16x32_bf16 v[96:99], v[172:175], v[240:243], v[96:99]
    ds_read_b128 v[168:171], v3 offset:61440
    s_waitcnt lgkmcnt(4)
    v_mfma_f32_16x16x32_bf16 v[100:103], v[172:175], v[244:247], v[100:103]
    buffer_load_dwordx4 v2, s[4:7], s43 offen sc1 lds
    v_mfma_f32_16x16x32_bf16 v[104:107], v[152:155], v[240:243], v[104:107]
    ds_read_b128 v[172:175], v3 offset:62464
    s_waitcnt lgkmcnt(4)
    v_mfma_f32_16x16x32_bf16 v[108:111], v[152:155], v[244:247], v[108:111]
    v_mfma_f32_16x16x32_bf16 v[112:115], v[156:159], v[240:243], v[112:115]
    ds_read_b128 v[152:155], v3 offset:63488
    s_waitcnt lgkmcnt(4)
    v_mfma_f32_16x16x32_bf16 v[116:119], v[156:159], v[244:247], v[116:119]
    buffer_load_dwordx4 v2, s[4:7], s43 offen offset:1024 sc1 lds
    v_mfma_f32_16x16x32_bf16 v[120:123], v[160:163], v[240:243], v[120:123]
    ds_read_b128 v[156:159], v3 offset:64512
    s_waitcnt lgkmcnt(4)
    v_mfma_f32_16x16x32_bf16 v[124:127], v[160:163], v[244:247], v[124:127]
    s_add_u32 m0, s42, 98304
    s_add_u32 s43, s95, 245760
    v_mfma_f32_16x16x32_bf16 v[128:131], v[164:167], v[240:243], v[128:131]
    ds_read_b128 v[160:163], v4 offset:0
    s_waitcnt lgkmcnt(4)
    v_mfma_f32_16x16x32_bf16 v[132:135], v[164:167], v[244:247], v[132:135]
    buffer_load_dwordx4 v2, s[4:7], s43 offen sc1 lds
    v_mfma_f32_16x16x32_bf16 v[136:139], v[168:171], v[240:243], v[136:139]
    ds_read_b128 v[164:167], v4 offset:1024
    s_waitcnt lgkmcnt(4)
    v_mfma_f32_16x16x32_bf16 v[140:143], v[168:171], v[244:247], v[140:143]
    buffer_load_dwordx4 v2, s[4:7], s43 offen offset:1024 sc1 lds
    v_mfma_f32_16x16x32_bf16 v[144:147], v[172:175], v[240:243], v[144:147]
    ds_read_b128 v[168:171], v4 offset:2048
    s_waitcnt lgkmcnt(4)
    v_mfma_f32_16x16x32_bf16 v[148:151], v[172:175], v[244:247], v[148:151]
    s_add_u32 m0, s42, 106496
    s_add_u32 s43, s95, 253952
    v_mfma_f32_16x16x32_bf16 v[40:43], v[152:155], v[248:251], v[40:43]
    ds_read_b128 v[172:175], v4 offset:3072
    s_waitcnt lgkmcnt(4)
    v_mfma_f32_16x16x32_bf16 v[44:47], v[152:155], v[252:255], v[44:47]
    buffer_load_dwordx4 v2, s[4:7], s43 offen sc1 lds
    v_mfma_f32_16x16x32_bf16 v[48:51], v[156:159], v[248:251], v[48:51]
    ds_read_b128 v[152:155], v4 offset:4096
    s_waitcnt lgkmcnt(4)
    v_mfma_f32_16x16x32_bf16 v[52:55], v[156:159], v[252:255], v[52:55]
    v_mfma_f32_16x16x32_bf16 v[56:59], v[160:163], v[248:251], v[56:59]
    ds_read_b128 v[156:159], v4 offset:5120
    s_waitcnt lgkmcnt(4)
    v_mfma_f32_16x16x32_bf16 v[60:63], v[160:163], v[252:255], v[60:63]
    buffer_load_dwordx4 v2, s[4:7], s43 offen offset:1024 sc1 lds
    v_mfma_f32_16x16x32_bf16 v[64:67], v[164:167], v[248:251], v[64:67]
    ds_read_b128 v[160:163], v4 offset:6144
    s_waitcnt lgkmcnt(4)
    v_mfma_f32_16x16x32_bf16 v[68:71], v[164:167], v[252:255], v[68:71]
    v_bfe_u32 v16, v0, 4, 1
    v_mul_u32_u24 v16, 55296, v16
    v_mfma_f32_16x16x32_bf16 v[72:75], v[168:171], v[248:251], v[72:75]
    ds_read_b128 v[164:167], v4 offset:7168
    s_waitcnt lgkmcnt(4)
    v_mfma_f32_16x16x32_bf16 v[76:79], v[168:171], v[252:255], v[76:79]
    buffer_load_dwordx4 v[240:243], v1, s[4:7], s58 offen offset:2048 sc1
    v_mfma_f32_16x16x32_bf16 v[80:83], v[172:175], v[248:251], v[80:83]
    ds_read_b128 v[168:171], v4 offset:8192
    s_waitcnt lgkmcnt(4)
    v_mfma_f32_16x16x32_bf16 v[84:87], v[172:175], v[252:255], v[84:87]
    v_add_u32 v13, v13, v16
    s_add_u32 s62, s70, 28672
    v_mfma_f32_16x16x32_bf16 v[88:91], v[152:155], v[248:251], v[88:91]
    ds_read_b128 v[172:175], v4 offset:9216
    s_waitcnt lgkmcnt(4)
    v_mfma_f32_16x16x32_bf16 v[92:95], v[152:155], v[252:255], v[92:95]
    buffer_load_dwordx4 v[244:247], v1, s[4:7], s59 offen offset:2048 sc1
    v_mfma_f32_16x16x32_bf16 v[96:99], v[156:159], v[248:251], v[96:99]
    ds_read_b128 v[152:155], v4 offset:10240
    s_waitcnt lgkmcnt(4)
    v_mfma_f32_16x16x32_bf16 v[100:103], v[156:159], v[252:255], v[100:103]
    buffer_load_dwordx4 a[140:143], v1, s[4:7], s62 offen offset:2048 sc1
    v_mfma_f32_16x16x32_bf16 v[104:107], v[160:163], v[248:251], v[104:107]
    ds_read_b128 v[156:159], v4 offset:11264
    s_waitcnt lgkmcnt(4)
    v_mfma_f32_16x16x32_bf16 v[108:111], v[160:163], v[252:255], v[108:111]
    v_mfma_f32_16x16x32_bf16 v[112:115], v[164:167], v[248:251], v[112:115]
    ds_read_b128 v[160:163], v4 offset:12288
    s_waitcnt lgkmcnt(4)
    v_mfma_f32_16x16x32_bf16 v[116:119], v[164:167], v[252:255], v[116:119]
    buffer_load_dwordx4 a[144:147], v1, s[4:7], s62 offen offset:3072 sc1
    v_mfma_f32_16x16x32_bf16 v[120:123], v[168:171], v[248:251], v[120:123]
    ds_read_b128 v[164:167], v4 offset:13312
    s_waitcnt lgkmcnt(4)
    v_mfma_f32_16x16x32_bf16 v[124:127], v[168:171], v[252:255], v[124:127]
    s_add_u32 s62, s70, 32768
    v_mfma_f32_16x16x32_bf16 v[128:131], v[172:175], v[248:251], v[128:131]
    ds_read_b128 v[168:171], v4 offset:14336
    s_waitcnt lgkmcnt(4)
    v_mfma_f32_16x16x32_bf16 v[132:135], v[172:175], v[252:255], v[132:135]
    buffer_load_dwordx4 a[148:151], v1, s[4:7], s62 offen offset:0 sc1
    v_mfma_f32_16x16x32_bf16 v[136:139], v[152:155], v[248:251], v[136:139]
    ds_read_b128 v[172:175], v4 offset:15360
    s_waitcnt lgkmcnt(4)
    v_mfma_f32_16x16x32_bf16 v[140:143], v[152:155], v[252:255], v[140:143]
    v_mfma_f32_16x16x32_bf16 v[144:147], v[156:159], v[248:251], v[144:147]
    ds_read_b128 v[152:155], v1 offset:0
    s_waitcnt lgkmcnt(4)
    v_mfma_f32_16x16x32_bf16 v[148:151], v[156:159], v[252:255], v[148:151]
    s_waitcnt vmcnt(33)
    s_barrier
    v_mfma_f32_16x16x32_bf16 v[40:43], v[160:163], v[176:179], v[40:43]
    ds_read_b128 v[156:159], v1 offset:1024
    s_waitcnt lgkmcnt(4)
    v_mfma_f32_16x16x32_bf16 v[44:47], v[160:163], v[180:183], v[44:47]
    buffer_load_dwordx4 v[248:251], v1, s[4:7], s58 offen offset:3072 sc1
    v_mfma_f32_16x16x32_bf16 v[48:51], v[164:167], v[176:179], v[48:51]
    ds_read_b128 v[160:163], v1 offset:2048
    s_waitcnt lgkmcnt(4)
    v_mfma_f32_16x16x32_bf16 v[52:55], v[164:167], v[180:183], v[52:55]
    buffer_load_dwordx4 v[252:255], v1, s[4:7], s59 offen offset:3072 sc1
    v_mfma_f32_16x16x32_bf16 v[56:59], v[168:171], v[176:179], v[56:59]
    ds_read_b128 v[164:167], v1 offset:3072
    s_waitcnt lgkmcnt(4)
    v_mfma_f32_16x16x32_bf16 v[60:63], v[168:171], v[180:183], v[60:63]
    s_add_u32 m0, s42, 114688
    s_add_u32 s43, s95, 262144
    v_mfma_f32_16x16x32_bf16 v[64:67], v[172:175], v[176:179], v[64:67]
    ds_read_b128 v[168:171], v1 offset:4096
    s_waitcnt lgkmcnt(4)
    v_mfma_f32_16x16x32_bf16 v[68:71], v[172:175], v[180:183], v[68:71]
    buffer_load_dwordx4 v2, s[4:7], s43 offen sc1 lds
    v_mfma_f32_16x16x32_bf16 v[72:75], v[152:155], v[176:179], v[72:75]
    ds_read_b128 v[172:175], v1 offset:5120
    s_waitcnt lgkmcnt(4)
    v_mfma_f32_16x16x32_bf16 v[76:79], v[152:155], v[180:183], v[76:79]
    v_mfma_f32_16x16x32_bf16 v[80:83], v[156:159], v[176:179], v[80:83]
    ds_read_b128 v[152:155], v1 offset:6144
    s_waitcnt lgkmcnt(4)
    v_mfma_f32_16x16x32_bf16 v[84:87], v[156:159], v[180:183], v[84:87]
    buffer_load_dwordx4 v2, s[4:7], s43 offen offset:1024 sc1 lds
    v_mfma_f32_16x16x32_bf16 v[88:91], v[160:163], v[176:179], v[88:91]
    ds_read_b128 v[156:159], v1 offset:7168
    s_waitcnt lgkmcnt(4)
    v_mfma_f32_16x16x32_bf16 v[92:95], v[160:163], v[180:183], v[92:95]
    s_add_u32 m0, s42, 122880
    s_add_u32 s43, s95, 270336
    v_mfma_f32_16x16x32_bf16 v[96:99], v[164:167], v[176:179], v[96:99]
    ds_read_b128 v[160:163], v1 offset:8192
    s_waitcnt lgkmcnt(4)
    v_mfma_f32_16x16x32_bf16 v[100:103], v[164:167], v[180:183], v[100:103]
    buffer_load_dwordx4 v2, s[4:7], s43 offen sc1 lds
    v_mfma_f32_16x16x32_bf16 v[104:107], v[168:171], v[176:179], v[104:107]
    ds_read_b128 v[164:167], v1 offset:9216
    s_waitcnt lgkmcnt(4)
    v_mfma_f32_16x16x32_bf16 v[108:111], v[168:171], v[180:183], v[108:111]
    v_mfma_f32_16x16x32_bf16 v[112:115], v[172:175], v[176:179], v[112:115]
    ds_read_b128 v[168:171], v1 offset:10240
    s_waitcnt lgkmcnt(4)
    v_mfma_f32_16x16x32_bf16 v[116:119], v[172:175], v[180:183], v[116:119]
    buffer_load_dwordx4 v2, s[4:7], s43 offen offset:1024 sc1 lds
    v_mfma_f32_16x16x32_bf16 v[120:123], v[152:155], v[176:179], v[120:123]
    ds_read_b128 v[172:175], v1 offset:11264
    s_waitcnt lgkmcnt(4)
    v_mfma_f32_16x16x32_bf16 v[124:127], v[152:155], v[180:183], v[124:127]
    s_add_u32 m0, s42, 131072
    s_add_u32 s43, s95, 278528
    v_mfma_f32_16x16x32_bf16 v[128:131], v[156:159], v[176:179], v[128:131]
    ds_read_b128 v[152:155], v1 offset:12288
    s_waitcnt lgkmcnt(4)
    v_mfma_f32_16x16x32_bf16 v[132:135], v[156:159], v[180:183], v[132:135]
    buffer_load_dwordx4 v2, s[4:7], s43 offen sc1 lds
    v_mfma_f32_16x16x32_bf16 v[136:139], v[160:163], v[176:179], v[136:139]
    ds_read_b128 v[156:159], v1 offset:13312
    s_waitcnt lgkmcnt(4)
    v_mfma_f32_16x16x32_bf16 v[140:143], v[160:163], v[180:183], v[140:143]
    buffer_load_dwordx4 v2, s[4:7], s43 offen offset:1024 sc1 lds
    v_mfma_f32_16x16x32_bf16 v[144:147], v[164:167], v[176:179], v[144:147]
    ds_read_b128 v[160:163], v1 offset:14336
    s_waitcnt lgkmcnt(4)
    v_mfma_f32_16x16x32_bf16 v[148:151], v[164:167], v[180:183], v[148:151]
    v_mfma_f32_16x16x32_bf16 v[40:43], v[168:171], v[184:187], v[40:43]
    ds_read_b128 v[164:167], v1 offset:15360
    s_waitcnt lgkmcnt(4)
    v_mfma_f32_16x16x32_bf16 v[44:47], v[168:171], v[188:191], v[44:47]
    buffer_load_dwordx4 a[152:155], v1, s[4:7], s62 offen offset:1024 sc1
    v_mfma_f32_16x16x32_bf16 v[48:51], v[172:175], v[184:187], v[48:51]
    ds_read_b128 v[168:171], v1 offset:16384
    s_waitcnt lgkmcnt(4)
    v_mfma_f32_16x16x32_bf16 v[52:55], v[172:175], v[188:191], v[52:55]
    v_mfma_f32_16x16x32_bf16 v[56:59], v[152:155], v[184:187], v[56:59]
    ds_read_b128 v[172:175], v1 offset:17408
    s_waitcnt lgkmcnt(4)
    v_mfma_f32_16x16x32_bf16 v[60:63], v[152:155], v[188:191], v[60:63]
    buffer_load_dwordx4 a[156:159], v1, s[4:7], s62 offen offset:2048 sc1
    v_mfma_f32_16x16x32_bf16 v[64:67], v[156:159], v[184:187], v[64:67]
    ds_read_b128 v[152:155], v1 offset:18432
    s_waitcnt lgkmcnt(4)
    v_mfma_f32_16x16x32_bf16 v[68:71], v[156:159], v[188:191], v[68:71]
    v_mfma_f32_16x16x32_bf16 v[72:75], v[160:163], v[184:187], v[72:75]
    ds_read_b128 v[156:159], v1 offset:19456
    s_waitcnt lgkmcnt(4)
    v_mfma_f32_16x16x32_bf16 v[76:79], v[160:163], v[188:191], v[76:79]
    buffer_load_dwordx4 a[160:163], v1, s[4:7], s62 offen offset:3072 sc1
    v_mfma_f32_16x16x32_bf16 v[80:83], v[164:167], v[184:187], v[80:83]
    ds_read_b128 v[160:163], v1 offset:20480
    s_waitcnt lgkmcnt(4)
    v_mfma_f32_16x16x32_bf16 v[84:87], v[164:167], v[188:191], v[84:87]
    s_add_u32 s62, s70, 36864
    v_mfma_f32_16x16x32_bf16 v[88:91], v[168:171], v[184:187], v[88:91]
    ds_read_b128 v[164:167], v1 offset:21504
    s_waitcnt lgkmcnt(4)
    v_mfma_f32_16x16x32_bf16 v[92:95], v[168:171], v[188:191], v[92:95]
    buffer_load_dwordx4 a[164:167], v1, s[4:7], s62 offen offset:0 sc1
    v_mfma_f32_16x16x32_bf16 v[96:99], v[172:175], v[184:187], v[96:99]
    ds_read_b128 v[168:171], v1 offset:22528
    s_waitcnt lgkmcnt(4)
    v_mfma_f32_16x16x32_bf16 v[100:103], v[172:175], v[188:191], v[100:103]
    buffer_load_dwordx4 a[168:171], v1, s[4:7], s62 offen offset:1024 sc1
    v_mfma_f32_16x16x32_bf16 v[104:107], v[152:155], v[184:187], v[104:107]
    ds_read_b128 v[172:175], v1 offset:23552
    s_waitcnt lgkmcnt(4)
    v_mfma_f32_16x16x32_bf16 v[108:111], v[152:155], v[188:191], v[108:111]
    v_mfma_f32_16x16x32_bf16 v[112:115], v[156:159], v[184:187], v[112:115]
    ds_read_b128 v[152:155], v1 offset:24576
    s_waitcnt lgkmcnt(4)
    v_mfma_f32_16x16x32_bf16 v[116:119], v[156:159], v[188:191], v[116:119]
    buffer_load_dwordx4 a[172:175], v1, s[4:7], s62 offen offset:2048 sc1
    v_mfma_f32_16x16x32_bf16 v[120:123], v[160:163], v[184:187], v[120:123]
    ds_read_b128 v[156:159], v1 offset:25600
    s_waitcnt lgkmcnt(4)
    v_mfma_f32_16x16x32_bf16 v[124:127], v[160:163], v[188:191], v[124:127]
    v_mfma_f32_16x16x32_bf16 v[128:131], v[164:167], v[184:187], v[128:131]
    ds_read_b128 v[160:163], v1 offset:26624
    s_waitcnt lgkmcnt(4)
    v_mfma_f32_16x16x32_bf16 v[132:135], v[164:167], v[188:191], v[132:135]
    buffer_load_dwordx4 a[0:3], v1, s[4:7], s62 offen offset:3072 sc1
    v_mfma_f32_16x16x32_bf16 v[136:139], v[168:171], v[184:187], v[136:139]
    ds_read_b128 v[164:167], v1 offset:27648
    s_waitcnt lgkmcnt(4)
    v_mfma_f32_16x16x32_bf16 v[140:143], v[168:171], v[188:191], v[140:143]
    s_add_u32 s62, s70, 40960
    v_mfma_f32_16x16x32_bf16 v[144:147], v[172:175], v[184:187], v[144:147]
    ds_read_b128 v[168:171], v1 offset:28672
    s_waitcnt lgkmcnt(4)
    v_mfma_f32_16x16x32_bf16 v[148:151], v[172:175], v[188:191], v[148:151]
    s_waitcnt vmcnt(42)
    s_barrier
    v_mfma_f32_16x16x32_bf16 v[40:43], v[152:155], v[192:195], v[40:43]
    ds_read_b128 v[172:175], v1 offset:29696
    s_waitcnt lgkmcnt(4)
    v_mfma_f32_16x16x32_bf16 v[44:47], v[152:155], v[196:199], v[44:47]
    buffer_load_dwordx4 a[4:7], v1, s[4:7], s62 offen offset:0 sc1
    v_mfma_f32_16x16x32_bf16 v[48:51], v[156:159], v[192:195], v[48:51]
    ds_read_b128 v[152:155], v1 offset:30720
    s_waitcnt lgkmcnt(4)
    v_mfma_f32_16x16x32_bf16 v[52:55], v[156:159], v[196:199], v[52:55]
    buffer_load_dwordx4 a[8:11], v1, s[4:7], s62 offen offset:1024 sc1
    v_mfma_f32_16x16x32_bf16 v[56:59], v[160:163], v[192:195], v[56:59]
    ds_read_b128 v[156:159], v1 offset:31744
    s_waitcnt lgkmcnt(4)
    v_mfma_f32_16x16x32_bf16 v[60:63], v[160:163], v[196:199], v[60:63]
    v_mfma_f32_16x16x32_bf16 v[64:67], v[164:167], v[192:195], v[64:67]
    ds_read_b128 v[160:163], v1 offset:32768
    s_waitcnt lgkmcnt(4)
    v_mfma_f32_16x16x32_bf16 v[68:71], v[164:167], v[196:199], v[68:71]
    buffer_load_dwordx4 a[12:15], v1, s[4:7], s62 offen offset:2048 sc1
    v_mfma_f32_16x16x32_bf16 v[72:75], v[168:171], v[192:195], v[72:75]
    ds_read_b128 v[164:167], v1 offset:33792
    s_waitcnt lgkmcnt(4)
    v_mfma_f32_16x16x32_bf16 v[76:79], v[168:171], v[196:199], v[76:79]
    v_mfma_f32_16x16x32_bf16 v[80:83], v[172:175], v[192:195], v[80:83]
    ds_read_b128 v[168:171], v1 offset:34816
    s_waitcnt lgkmcnt(4)
    v_mfma_f32_16x16x32_bf16 v[84:87], v[172:175], v[196:199], v[84:87]
    buffer_load_dwordx4 a[16:19], v1, s[4:7], s62 offen offset:3072 sc1
    v_mfma_f32_16x16x32_bf16 v[88:91], v[152:155], v[192:195], v[88:91]
    ds_read_b128 v[172:175], v1 offset:35840
    s_waitcnt lgkmcnt(4)
    v_mfma_f32_16x16x32_bf16 v[92:95], v[152:155], v[196:199], v[92:95]
    s_add_u32 s62, s70, 45056
    v_mfma_f32_16x16x32_bf16 v[96:99], v[156:159], v[192:195], v[96:99]
    ds_read_b128 v[152:155], v1 offset:36864
    s_waitcnt lgkmcnt(4)
    v_mfma_f32_16x16x32_bf16 v[100:103], v[156:159], v[196:199], v[100:103]
    buffer_load_dwordx4 a[20:23], v1, s[4:7], s62 offen offset:0 sc1
    v_mfma_f32_16x16x32_bf16 v[104:107], v[160:163], v[192:195], v[104:107]
    ds_read_b128 v[156:159], v1 offset:37888
    s_waitcnt lgkmcnt(4)
    v_mfma_f32_16x16x32_bf16 v[108:111], v[160:163], v[196:199], v[108:111]
    v_mfma_f32_16x16x32_bf16 v[112:115], v[164:167], v[192:195], v[112:115]
    ds_read_b128 v[160:163], v1 offset:38912
    s_waitcnt lgkmcnt(4)
    v_mfma_f32_16x16x32_bf16 v[116:119], v[164:167], v[196:199], v[116:119]
    buffer_load_dwordx4 a[24:27], v1, s[4:7], s62 offen offset:1024 sc1
    v_mfma_f32_16x16x32_bf16 v[120:123], v[168:171], v[192:195], v[120:123]
    ds_read_b128 v[164:167], v1 offset:39936
    s_waitcnt lgkmcnt(4)
    v_mfma_f32_16x16x32_bf16 v[124:127], v[168:171], v[196:199], v[124:127]
    buffer_load_dwordx4 a[28:31], v1, s[4:7], s62 offen offset:2048 sc1
    v_mfma_f32_16x16x32_bf16 v[128:131], v[172:175], v[192:195], v[128:131]
    ds_read_b128 v[168:171], v1 offset:40960
    s_waitcnt lgkmcnt(4)
    v_mfma_f32_16x16x32_bf16 v[132:135], v[172:175], v[196:199], v[132:135]
    v_mfma_f32_16x16x32_bf16 v[136:139], v[152:155], v[192:195], v[136:139]
    ds_read_b128 v[172:175], v1 offset:41984
    s_waitcnt lgkmcnt(4)
    v_mfma_f32_16x16x32_bf16 v[140:143], v[152:155], v[196:199], v[140:143]
    buffer_load_dwordx4 a[32:35], v1, s[4:7], s62 offen offset:3072 sc1
    v_mfma_f32_16x16x32_bf16 v[144:147], v[156:159], v[192:195], v[144:147]
    ds_read_b128 v[152:155], v1 offset:43008
    s_waitcnt lgkmcnt(4)
    v_mfma_f32_16x16x32_bf16 v[148:151], v[156:159], v[196:199], v[148:151]
    s_add_u32 s62, s70, 49152
    v_mfma_f32_16x16x32_bf16 v[40:43], v[160:163], v[200:203], v[40:43]
    ds_read_b128 v[156:159], v1 offset:44032
    s_waitcnt lgkmcnt(4)
    v_mfma_f32_16x16x32_bf16 v[44:47], v[160:163], v[204:207], v[44:47]
    buffer_load_dwordx4 a[36:39], v1, s[4:7], s62 offen offset:0 sc1
    v_mfma_f32_16x16x32_bf16 v[48:51], v[164:167], v[200:203], v[48:51]
    ds_read_b128 v[160:163], v1 offset:45056
    s_waitcnt lgkmcnt(4)
    v_mfma_f32_16x16x32_bf16 v[52:55], v[164:167], v[204:207], v[52:55]
    v_mfma_f32_16x16x32_bf16 v[56:59], v[168:171], v[200:203], v[56:59]
    ds_read_b128 v[164:167], v1 offset:46080
    s_waitcnt lgkmcnt(4)
    v_mfma_f32_16x16x32_bf16 v[60:63], v[168:171], v[204:207], v[60:63]
    buffer_load_dwordx4 a[40:43], v1, s[4:7], s62 offen offset:1024 sc1
    v_mfma_f32_16x16x32_bf16 v[64:67], v[172:175], v[200:203], v[64:67]
    ds_read_b128 v[168:171], v1 offset:47104
    s_waitcnt lgkmcnt(4)
    v_mfma_f32_16x16x32_bf16 v[68:71], v[172:175], v[204:207], v[68:71]
    v_mfma_f32_16x16x32_bf16 v[72:75], v[152:155], v[200:203], v[72:75]
    ds_read_b128 v[172:175], v1 offset:48128
    s_waitcnt lgkmcnt(4)
    v_mfma_f32_16x16x32_bf16 v[76:79], v[152:155], v[204:207], v[76:79]
    buffer_load_dwordx4 a[44:47], v1, s[4:7], s62 offen offset:2048 sc1
    v_mfma_f32_16x16x32_bf16 v[80:83], v[156:159], v[200:203], v[80:83]
    ds_read_b128 v[152:155], v1 offset:49152
    s_waitcnt lgkmcnt(4)
    v_mfma_f32_16x16x32_bf16 v[84:87], v[156:159], v[204:207], v[84:87]
    buffer_load_dwordx4 a[48:51], v1, s[4:7], s62 offen offset:3072 sc1
    v_mfma_f32_16x16x32_bf16 v[88:91], v[160:163], v[200:203], v[88:91]
    ds_read_b128 v[156:159], v1 offset:50176
    s_waitcnt lgkmcnt(4)
    v_mfma_f32_16x16x32_bf16 v[92:95], v[160:163], v[204:207], v[92:95]
    s_add_u32 s62, s70, 53248
    v_mfma_f32_16x16x32_bf16 v[96:99], v[164:167], v[200:203], v[96:99]
    ds_read_b128 v[160:163], v1 offset:51200
    s_waitcnt lgkmcnt(4)
    v_mfma_f32_16x16x32_bf16 v[100:103], v[164:167], v[204:207], v[100:103]
    buffer_load_dwordx4 a[52:55], v1, s[4:7], s62 offen offset:0 sc1
    v_mfma_f32_16x16x32_bf16 v[104:107], v[168:171], v[200:203], v[104:107]
    ds_read_b128 v[164:167], v1 offset:52224
    s_waitcnt lgkmcnt(4)
    v_mfma_f32_16x16x32_bf16 v[108:111], v[168:171], v[204:207], v[108:111]
    s_waitcnt vmcnt(20)
    s_barrier
    v_mfma_f32_16x16x32_bf16 v[112:115], v[172:175], v[200:203], v[112:115]
    ds_read_b128 v[168:171], v1 offset:53248
    s_waitcnt lgkmcnt(4)
    v_mfma_f32_16x16x32_bf16 v[116:119], v[172:175], v[204:207], v[116:119]
    buffer_load_dwordx4 a[56:59], v1, s[4:7], s62 offen offset:1024 sc1
    v_mfma_f32_16x16x32_bf16 v[120:123], v[152:155], v[200:203], v[120:123]
    ds_read_b128 v[172:175], v1 offset:54272
    s_waitcnt lgkmcnt(4)
    v_mfma_f32_16x16x32_bf16 v[124:127], v[152:155], v[204:207], v[124:127]
    v_mfma_f32_16x16x32_bf16 v[128:131], v[156:159], v[200:203], v[128:131]
    ds_read_b128 v[152:155], v3 offset:2048
    s_waitcnt lgkmcnt(4)
    v_mfma_f32_16x16x32_bf16 v[132:135], v[156:159], v[204:207], v[132:135]
    buffer_load_dwordx4 a[60:63], v1, s[4:7], s62 offen offset:2048 sc1
    v_mfma_f32_16x16x32_bf16 v[136:139], v[160:163], v[200:203], v[136:139]
    ds_read_b128 v[156:159], v3 offset:3072
    s_waitcnt lgkmcnt(4)
    v_mfma_f32_16x16x32_bf16 v[140:143], v[160:163], v[204:207], v[140:143]
    v_mfma_f32_16x16x32_bf16 v[144:147], v[164:167], v[200:203], v[144:147]
    ds_read_b128 v[160:163], v3 offset:16384
    s_waitcnt lgkmcnt(4)
    v_mfma_f32_16x16x32_bf16 v[148:151], v[164:167], v[204:207], v[148:151]
    buffer_load_dwordx4 a[64:67], v1, s[4:7], s62 offen offset:3072 sc1
    v_mfma_f32_16x16x32_bf16 v[40:43], v[168:171], v[208:211], v[40:43]
    ds_read_b128 v[164:167], v3 offset:17408
    s_waitcnt lgkmcnt(4)
    v_mfma_f32_16x16x32_bf16 v[44:47], v[168:171], v[212:215], v[44:47]
    s_add_u32 s62, s70, 57344
    v_mfma_f32_16x16x32_bf16 v[48:51], v[172:175], v[208:211], v[48:51]
    ds_read_b128 v[168:171], v3 offset:30720
    s_waitcnt lgkmcnt(4)
    v_mfma_f32_16x16x32_bf16 v[52:55], v[172:175], v[212:215], v[52:55]
    ds_read_b128 v[176:179], v12 offset:0
    ds_read_b128 v[180:183], v12 offset:512
    v_mfma_f32_16x16x32_bf16 v[40:43], v[152:155], v[216:219], v[40:43]
    ds_read_b128 v[172:175], v3 offset:31744
    s_waitcnt lgkmcnt(6)
    v_mfma_f32_16x16x32_bf16 v[44:47], v[152:155], v[220:223], v[44:47]
    ds_read_b128 v[184:187], v12 offset:64
    ds_read_b128 v[188:191], v12 offset:576
    v_mfma_f32_16x16x32_bf16 v[48:51], v[156:159], v[216:219], v[48:51]
    ds_read_b128 v[152:155], v3 offset:45056
    s_waitcnt lgkmcnt(8)
    v_mfma_f32_16x16x32_bf16 v[52:55], v[156:159], v[220:223], v[52:55]
    buffer_load_dwordx4 a[68:71], v1, s[4:7], s62 offen offset:0 sc1
    v_mfma_f32_16x16x32_bf16 v[40:43], v[160:163], v[224:227], v[40:43]
    ds_read_b128 v[156:159], v3 offset:46080
    s_waitcnt lgkmcnt(8)
    v_mfma_f32_16x16x32_bf16 v[44:47], v[160:163], v[228:231], v[44:47]
    buffer_load_dwordx4 a[72:75], v1, s[4:7], s62 offen offset:1024 sc1
    v_mfma_f32_16x16x32_bf16 v[48:51], v[164:167], v[224:227], v[48:51]
    ds_read_b128 v[160:163], v3 offset:59392
    s_waitcnt lgkmcnt(8)
    v_mfma_f32_16x16x32_bf16 v[52:55], v[164:167], v[228:231], v[52:55]
    v_mfma_f32_16x16x32_bf16 v[40:43], v[168:171], v[232:235], v[40:43]
    ds_read_b128 v[164:167], v3 offset:60416
    s_waitcnt lgkmcnt(6)
    v_mfma_f32_16x16x32_bf16 v[44:47], v[168:171], v[236:239], v[44:47]
    buffer_load_dwordx4 a[76:79], v1, s[4:7], s62 offen offset:2048 sc1
    v_mfma_f32_16x16x32_bf16 v[48:51], v[172:175], v[232:235], v[48:51]
    ds_read_b128 v[168:171], v1 offset:55296
    s_waitcnt lgkmcnt(4)
    v_mfma_f32_16x16x32_bf16 v[52:55], v[172:175], v[236:239], v[52:55]
    v_mfma_f32_16x16x32_bf16 v[40:43], v[152:155], v[240:243], v[40:43]
    ds_read_b128 v[172:175], v1 offset:56320
    s_waitcnt lgkmcnt(4)
    v_mfma_f32_16x16x32_bf16 v[44:47], v[152:155], v[244:247], v[44:47]
    buffer_load_dwordx4 a[80:83], v1, s[4:7], s62 offen offset:3072 sc1
    v_mfma_f32_16x16x32_bf16 v[48:51], v[156:159], v[240:243], v[48:51]
    ds_read_b128 v[152:155], v3 offset:4096
    s_waitcnt lgkmcnt(4)
    v_mfma_f32_16x16x32_bf16 v[52:55], v[156:159], v[244:247], v[52:55]
    s_add_u32 s62, s70, 61440
    v_mfma_f32_16x16x32_bf16 v[40:43], v[160:163], v[248:251], v[40:43]
    ds_read_b128 v[156:159], v3 offset:5120
    s_waitcnt lgkmcnt(4)
    v_mfma_f32_16x16x32_bf16 v[44:47], v[160:163], v[252:255], v[44:47]
    buffer_load_dwordx4 a[84:87], v1, s[4:7], s62 offen offset:0 sc1
    v_mfma_f32_16x16x32_bf16 v[48:51], v[164:167], v[248:251], v[48:51]
    ds_read_b128 v[160:163], v3 offset:18432
    s_waitcnt lgkmcnt(4)
    v_mfma_f32_16x16x32_bf16 v[52:55], v[164:167], v[252:255], v[52:55]
    v_mfma_f32_16x16x32_bf16 v[56:59], v[168:171], v[208:211], v[56:59]
    ds_read_b128 v[164:167], v3 offset:19456
    s_waitcnt lgkmcnt(4)
    v_mfma_f32_16x16x32_bf16 v[60:63], v[168:171], v[212:215], v[60:63]
    buffer_load_dwordx4 a[88:91], v1, s[4:7], s62 offen offset:1024 sc1
    v_mfma_f32_16x16x32_bf16 v[64:67], v[172:175], v[208:211], v[64:67]
    ds_read_b128 v[168:171], v3 offset:32768
    s_waitcnt lgkmcnt(4)
    v_mfma_f32_16x16x32_bf16 v[68:71], v[172:175], v[212:215], v[68:71]
    s_cmp_lg_u32 s41, 0
    s_cbranch_scc1 L_l0_65
    s_add_u32 m0, s42, 0
    s_add_u32 s43, s77, 0
    buffer_load_dwordx4 v2, s[4:7], s43 offen sc1 lds
    buffer_load_dwordx4 v2, s[4:7], s43 offen offset:1024 sc1 lds
L_l0_65:
    v_mfma_f32_16x16x32_bf16 v[56:59], v[152:155], v[216:219], v[56:59]
    ds_read_b128 v[172:175], v3 offset:33792
    s_waitcnt lgkmcnt(4)
    v_mfma_f32_16x16x32_bf16 v[60:63], v[152:155], v[220:223], v[60:63]
    v_fmac_f32 v40, v176, v10
    v_mfma_f32_16x16x32_bf16 v[64:67], v[156:159], v[216:219], v[64:67]
    ds_read_b128 v[152:155], v3 offset:47104
    s_waitcnt lgkmcnt(4)
    v_mfma_f32_16x16x32_bf16 v[68:71], v[156:159], v[220:223], v[68:71]
    v_fmac_f32 v48, v180, v10
    v_fmac_f32 v41, v177, v10
    v_mfma_f32_16x16x32_bf16 v[56:59], v[160:163], v[224:227], v[56:59]
    ds_read_b128 v[156:159], v3 offset:48128
    s_waitcnt lgkmcnt(4)
    v_mfma_f32_16x16x32_bf16 v[60:63], v[160:163], v[228:231], v[60:63]
    v_fmac_f32 v49, v181, v10
    v_fmac_f32 v42, v178, v10
    v_mfma_f32_16x16x32_bf16 v[64:67], v[164:167], v[224:227], v[64:67]
    ds_read_b128 v[160:163], v3 offset:61440
    s_waitcnt lgkmcnt(4)
    v_mfma_f32_16x16x32_bf16 v[68:71], v[164:167], v[228:231], v[68:71]
    v_fmac_f32 v50, v182, v10
    v_fmac_f32 v43, v179, v10
    v_mfma_f32_16x16x32_bf16 v[56:59], v[168:171], v[232:235], v[56:59]
    ds_read_b128 v[164:167], v3 offset:62464
    s_waitcnt lgkmcnt(4)
    v_mfma_f32_16x16x32_bf16 v[60:63], v[168:171], v[236:239], v[60:63]
    v_fmac_f32 v51, v183, v10
    v_mul_f32 v48, v48, v11
    v_mfma_f32_16x16x32_bf16 v[64:67], v[172:175], v[232:235], v[64:67]
    ds_read_b128 v[168:171], v1 offset:57344
    s_waitcnt lgkmcnt(4)
    v_mfma_f32_16x16x32_bf16 v[68:71], v[172:175], v[236:239], v[68:71]
    v_mul_f32 v49, v49, v11
    v_mul_f32 v50, v50, v11
    v_mfma_f32_16x16x32_bf16 v[56:59], v[152:155], v[240:243], v[56:59]
    ds_read_b128 v[172:175], v1 offset:58368
    s_waitcnt lgkmcnt(4)
    v_mfma_f32_16x16x32_bf16 v[60:63], v[152:155], v[244:247], v[60:63]
    v_mul_f32 v51, v51, v11
    v_mul_f32 v48, v48, v40
    v_mfma_f32_16x16x32_bf16 v[64:67], v[156:159], v[240:243], v[64:67]
    ds_read_b128 v[152:155], v3 offset:6144
    s_waitcnt lgkmcnt(4)
    v_mfma_f32_16x16x32_bf16 v[68:71], v[156:159], v[244:247], v[68:71]
    v_mul_f32 v49, v49, v41
    v_mul_f32 v50, v50, v42
    v_mfma_f32_16x16x32_bf16 v[56:59], v[160:163], v[248:251], v[56:59]
    ds_read_b128 v[156:159], v3 offset:7168
    s_waitcnt lgkmcnt(4)
    v_mfma_f32_16x16x32_bf16 v[60:63], v[160:163], v[252:255], v[60:63]
    v_mul_f32 v51, v51, v43
    v_cvt_pk_bf16_f32 v40, v48, v49
    v_mfma_f32_16x16x32_bf16 v[64:67], v[164:167], v[248:251], v[64:67]
    ds_read_b128 v[160:163], v3 offset:20480
    s_waitcnt lgkmcnt(4)
    v_mfma_f32_16x16x32_bf16 v[68:71], v[164:167], v[252:255], v[68:71]
    v_cvt_pk_bf16_f32 v41, v50, v51
    v_fmac_f32 v44, v176, v14
    v_mfma_f32_16x16x32_bf16 v[72:75], v[168:171], v[208:211], v[72:75]
    ds_read_b128 v[164:167], v3 offset:21504
    s_waitcnt lgkmcnt(4)
    v_mfma_f32_16x16x32_bf16 v[76:79], v[168:171], v[212:215], v[76:79]
    v_fmac_f32 v52, v180, v14
    v_fmac_f32 v45, v177, v14
    v_mfma_f32_16x16x32_bf16 v[80:83], v[172:175], v[208:211], v[80:83]
    ds_read_b128 v[168:171], v3 offset:34816
    s_waitcnt lgkmcnt(4)
    v_mfma_f32_16x16x32_bf16 v[84:87], v[172:175], v[212:215], v[84:87]
    v_fmac_f32 v53, v181, v14
    v_fmac_f32 v46, v178, v14
    v_mfma_f32_16x16x32_bf16 v[72:75], v[152:155], v[216:219], v[72:75]
    ds_read_b128 v[172:175], v3 offset:35840
    s_waitcnt lgkmcnt(4)
    v_mfma_f32_16x16x32_bf16 v[76:79], v[152:155], v[220:223], v[76:79]
    v_fmac_f32 v54, v182, v14
    v_fmac_f32 v47, v179, v14
    v_mfma_f32_16x16x32_bf16 v[80:83], v[156:159], v[216:219], v[80:83]
    ds_read_b128 v[152:155], v3 offset:49152
    s_waitcnt lgkmcnt(4)
    v_mfma_f32_16x16x32_bf16 v[84:87], v[156:159], v[220:223], v[84:87]
    v_fmac_f32 v55, v183, v14
    v_mul_f32 v52, v52, v15
    v_mfma_f32_16x16x32_bf16 v[72:75], v[160:163], v[224:227], v[72:75]
    ds_read_b128 v[156:159], v3 offset:50176
    s_waitcnt lgkmcnt(4)
    v_mfma_f32_16x16x32_bf16 v[76:79], v[160:163], v[228:231], v[76:79]
    v_mul_f32 v53, v53, v15
    v_mul_f32 v54, v54, v15
    v_mfma_f32_16x16x32_bf16 v[80:83], v[164:167], v[224:227], v[80:83]
    ds_read_b128 v[160:163], v3 offset:63488
    s_waitcnt lgkmcnt(4)
    v_mfma_f32_16x16x32_bf16 v[84:87], v[164:167], v[228:231], v[84:87]
    v_mul_f32 v55, v55, v15
    v_mul_f32 v52, v52, v44
    v_mfma_f32_16x16x32_bf16 v[72:75], v[168:171], v[232:235], v[72:75]
    ds_read_b128 v[164:167], v3 offset:64512
    s_waitcnt lgkmcnt(4)
    v_mfma_f32_16x16x32_bf16 v[76:79], v[168:171], v[236:239], v[76:79]
    v_mul_f32 v53, v53, v45
    v_mul_f32 v54, v54, v46
    v_mfma_f32_16x16x32_bf16 v[80:83], v[172:175], v[232:235], v[80:83]
    ds_read_b128 v[168:171], v1 offset:59392
    s_waitcnt lgkmcnt(4)
    v_mfma_f32_16x16x32_bf16 v[84:87], v[172:175], v[236:239], v[84:87]
    v_mul_f32 v55, v55, v47
    v_cvt_pk_bf16_f32 v44, v52, v53
    v_mfma_f32_16x16x32_bf16 v[72:75], v[152:155], v[240:243], v[72:75]
    ds_read_b128 v[172:175], v1 offset:60416
    s_waitcnt lgkmcnt(4)
    v_mfma_f32_16x16x32_bf16 v[76:79], v[152:155], v[244:247], v[76:79]
    v_cvt_pk_bf16_f32 v45, v54, v55
    ds_read_b128 v[176:179], v12 offset:128
    v_mfma_f32_16x16x32_bf16 v[80:83], v[156:159], v[240:243], v[80:83]
    ds_read_b128 v[152:155], v3 offset:8192
    s_waitcnt lgkmcnt(5)
    v_mfma_f32_16x16x32_bf16 v[84:87], v[156:159], v[244:247], v[84:87]
    ds_read_b128 v[180:183], v12 offset:640
    v_mfma_f32_16x16x32_bf16 v[72:75], v[160:163], v[248:251], v[72:75]
    ds_read_b128 v[156:159], v3 offset:9216
    s_waitcnt lgkmcnt(6)
    v_mfma_f32_16x16x32_bf16 v[76:79], v[160:163], v[252:255], v[76:79]
    s_cmp_lg_u32 s41, 0
    s_cbranch_scc1 L_l0_66
    s_add_u32 m0, s42, 8192
    s_add_u32 s43, s77, 8192
    buffer_load_dwordx4 v2, s[4:7], s43 offen sc1 lds
    buffer_load_dwordx4 v2, s[4:7], s43 offen offset:1024 sc1 lds
L_l0_66:
    v_mfma_f32_16x16x32_bf16 v[80:83], v[164:167], v[248:251], v[80:83]
    ds_read_b128 v[160:163], v3 offset:22528
    s_waitcnt lgkmcnt(6)
    v_mfma_f32_16x16x32_bf16 v[84:87], v[164:167], v[252:255], v[84:87]
    v_fmac_f32 v56, v184, v10
    v_mfma_f32_16x16x32_bf16 v[88:91], v[168:171], v[208:211], v[88:91]
    ds_read_b128 v[164:167], v3 offset:23552
    s_waitcnt lgkmcnt(6)
    v_mfma_f32_16x16x32_bf16 v[92:95], v[168:171], v[212:215], v[92:95]
    v_fmac_f32 v64, v188, v10
    v_fmac_f32 v57, v185, v10
    v_mfma_f32_16x16x32_bf16 v[96:99], v[172:175], v[208:211], v[96:99]
    ds_read_b128 v[168:171], v3 offset:36864
    s_waitcnt lgkmcnt(5)
    v_mfma_f32_16x16x32_bf16 v[100:103], v[172:175], v[212:215], v[100:103]
    v_fmac_f32 v65, v189, v10
    v_fmac_f32 v58, v186, v10
    v_mfma_f32_16x16x32_bf16 v[88:91], v[152:155], v[216:219], v[88:91]
    ds_read_b128 v[172:175], v3 offset:37888
    s_waitcnt lgkmcnt(4)
    v_mfma_f32_16x16x32_bf16 v[92:95], v[152:155], v[220:223], v[92:95]
    v_fmac_f32 v66, v190, v10
    v_fmac_f32 v59, v187, v10
    v_mfma_f32_16x16x32_bf16 v[96:99], v[156:159], v[216:219], v[96:99]
    ds_read_b128 v[152:155], v3 offset:51200
    s_waitcnt lgkmcnt(4)
    v_mfma_f32_16x16x32_bf16 v[100:103], v[156:159], v[220:223], v[100:103]
    v_fmac_f32 v67, v191, v10
    v_mul_f32 v64, v64, v11
    v_mfma_f32_16x16x32_bf16 v[88:91], v[160:163], v[224:227], v[88:91]
    ds_read_b128 v[156:159], v3 offset:52224
    s_waitcnt lgkmcnt(4)
    v_mfma_f32_16x16x32_bf16 v[92:95], v[160:163], v[228:231], v[92:95]
    v_mul_f32 v65, v65, v11
    v_mul_f32 v66, v66, v11
    v_mfma_f32_16x16x32_bf16 v[96:99], v[164:167], v[224:227], v[96:99]
    ds_read_b128 v[160:163], v4 offset:0
    s_waitcnt lgkmcnt(4)
    v_mfma_f32_16x16x32_bf16 v[100:103], v[164:167], v[228:231], v[100:103]
    v_mul_f32 v67, v67, v11
    v_mul_f32 v64, v64, v56
    v_mfma_f32_16x16x32_bf16 v[88:91], v[168:171], v[232:235], v[88:91]
    ds_read_b128 v[164:167], v4 offset:1024
    s_waitcnt lgkmcnt(4)
    v_mfma_f32_16x16x32_bf16 v[92:95], v[168:171], v[236:239], v[92:95]
    v_mul_f32 v65, v65, v57
    v_mul_f32 v66, v66, v58
    v_mfma_f32_16x16x32_bf16 v[96:99], v[172:175], v[232:235], v[96:99]
    ds_read_b128 v[168:171], v1 offset:61440
    s_waitcnt lgkmcnt(4)
    v_mfma_f32_16x16x32_bf16 v[100:103], v[172:175], v[236:239], v[100:103]
    v_mul_f32 v67, v67, v59
    v_cvt_pk_bf16_f32 v42, v64, v65
    v_mfma_f32_16x16x32_bf16 v[88:91], v[152:155], v[240:243], v[88:91]
    ds_read_b128 v[172:175], v1 offset:62464
    s_waitcnt lgkmcnt(4)
    v_mfma_f32_16x16x32_bf16 v[92:95], v[152:155], v[244:247], v[92:95]
    v_cvt_pk_bf16_f32 v43, v66, v67
    v_mfma_f32_16x16x32_bf16 v[96:99], v[156:159], v[240:243], v[96:99]
    ds_read_b128 v[152:155], v3 offset:10240
    s_waitcnt lgkmcnt(4)
    v_mfma_f32_16x16x32_bf16 v[100:103], v[156:159], v[244:247], v[100:103]
    buffer_store_dwordx4 v[40:43], v1, s[4:7], s96 offen offset:0 sc1
    v_mfma_f32_16x16x32_bf16 v[88:91], v[160:163], v[248:251], v[88:91]
    ds_read_b128 v[156:159], v3 offset:11264
    s_waitcnt lgkmcnt(4)
    v_mfma_f32_16x16x32_bf16 v[92:95], v[160:163], v[252:255], v[92:95]
    v_fmac_f32 v60, v184, v14
    v_fmac_f32 v68, v188, v14
    v_mfma_f32_16x16x32_bf16 v[96:99], v[164:167], v[248:251], v[96:99]
    ds_read_b128 v[160:163], v3 offset:24576
    s_waitcnt lgkmcnt(4)
    v_mfma_f32_16x16x32_bf16 v[100:103], v[164:167], v[252:255], v[100:103]
    v_fmac_f32 v61, v185, v14
    v_fmac_f32 v69, v189, v14
    v_mfma_f32_16x16x32_bf16 v[104:107], v[168:171], v[208:211], v[104:107]
    ds_read_b128 v[164:167], v3 offset:25600
    s_waitcnt lgkmcnt(4)
    v_mfma_f32_16x16x32_bf16 v[108:111], v[168:171], v[212:215], v[108:111]
    v_fmac_f32 v62, v186, v14
    v_fmac_f32 v70, v190, v14
    v_mfma_f32_16x16x32_bf16 v[112:115], v[172:175], v[208:211], v[112:115]
    ds_read_b128 v[168:171], v3 offset:38912
    s_waitcnt lgkmcnt(4)
    v_mfma_f32_16x16x32_bf16 v[116:119], v[172:175], v[212:215], v[116:119]
    v_fmac_f32 v63, v187, v14
    v_fmac_f32 v71, v191, v14
    v_mfma_f32_16x16x32_bf16 v[104:107], v[152:155], v[216:219], v[104:107]
    ds_read_b128 v[172:175], v3 offset:39936
    s_waitcnt lgkmcnt(4)
    v_mfma_f32_16x16x32_bf16 v[108:111], v[152:155], v[220:223], v[108:111]
    v_mul_f32 v68, v68, v15
    v_mul_f32 v69, v69, v15
    v_mfma_f32_16x16x32_bf16 v[112:115], v[156:159], v[216:219], v[112:115]
    ds_read_b128 v[152:155], v3 offset:53248
    s_waitcnt lgkmcnt(4)
    v_mfma_f32_16x16x32_bf16 v[116:119], v[156:159], v[220:223], v[116:119]
    v_mul_f32 v70, v70, v15
    v_mul_f32 v71, v71, v15
    v_mfma_f32_16x16x32_bf16 v[104:107], v[160:163], v[224:227], v[104:107]
    ds_read_b128 v[156:159], v3 offset:54272
    s_waitcnt lgkmcnt(4)
    v_mfma_f32_16x16x32_bf16 v[108:111], v[160:163], v[228:231], v[108:111]
    v_mul_f32 v68, v68, v60
    v_mul_f32 v69, v69, v61
    v_mfma_f32_16x16x32_bf16 v[112:115], v[164:167], v[224:227], v[112:115]
    ds_read_b128 v[160:163], v4 offset:2048
    s_waitcnt lgkmcnt(4)
    v_mfma_f32_16x16x32_bf16 v[116:119], v[164:167], v[228:231], v[116:119]
    v_mul_f32 v70, v70, v62
    v_mul_f32 v71, v71, v63
    v_mfma_f32_16x16x32_bf16 v[104:107], v[168:171], v[232:235], v[104:107]
    ds_read_b128 v[164:167], v4 offset:3072
    s_waitcnt lgkmcnt(4)
    v_mfma_f32_16x16x32_bf16 v[108:111], v[168:171], v[236:239], v[108:111]
    v_cvt_pk_bf16_f32 v46, v68, v69
    v_cvt_pk_bf16_f32 v47, v70, v71
    v_mfma_f32_16x16x32_bf16 v[112:115], v[172:175], v[232:235], v[112:115]
    ds_read_b128 v[168:171], v1 offset:63488
    s_waitcnt lgkmcnt(4)
    v_mfma_f32_16x16x32_bf16 v[116:119], v[172:175], v[236:239], v[116:119]
    buffer_store_dwordx4 v[44:47], v1, s[4:7], s97 offen offset:0 sc1
    v_mfma_f32_16x16x32_bf16 v[104:107], v[152:155], v[240:243], v[104:107]
    ds_read_b128 v[172:175], v1 offset:64512
    s_waitcnt lgkmcnt(4)
    v_mfma_f32_16x16x32_bf16 v[108:111], v[152:155], v[244:247], v[108:111]
    ds_read_b128 v[184:187], v12 offset:192
    ds_read_b128 v[188:191], v12 offset:704
    v_mfma_f32_16x16x32_bf16 v[112:115], v[156:159], v[240:243], v[112:115]
    ds_read_b128 v[152:155], v3 offset:12288
    s_waitcnt lgkmcnt(6)
    v_mfma_f32_16x16x32_bf16 v[116:119], v[156:159], v[244:247], v[116:119]
    s_cmp_lg_u32 s41, 0
    s_cbranch_scc1 L_l0_67
    s_add_u32 m0, s42, 16384
    s_add_u32 s43, s77, 16384
    buffer_load_dwordx4 v2, s[4:7], s43 offen sc1 lds
    buffer_load_dwordx4 v2, s[4:7], s43 offen offset:1024 sc1 lds
L_l0_67:
    v_mfma_f32_16x16x32_bf16 v[104:107], v[160:163], v[248:251], v[104:107]
    ds_read_b128 v[156:159], v3 offset:13312
    s_waitcnt lgkmcnt(6)
    v_mfma_f32_16x16x32_bf16 v[108:111], v[160:163], v[252:255], v[108:111]
    v_fmac_f32 v72, v176, v10
    v_mfma_f32_16x16x32_bf16 v[112:115], v[164:167], v[248:251], v[112:115]
    ds_read_b128 v[160:163], v3 offset:26624
    s_waitcnt lgkmcnt(6)
    v_mfma_f32_16x16x32_bf16 v[116:119], v[164:167], v[252:255], v[116:119]
    v_fmac_f32 v80, v180, v10
    v_fmac_f32 v73, v177, v10
    v_mfma_f32_16x16x32_bf16 v[120:123], v[168:171], v[208:211], v[120:123]
    ds_read_b128 v[164:167], v3 offset:27648
    s_waitcnt lgkmcnt(6)
    v_mfma_f32_16x16x32_bf16 v[124:127], v[168:171], v[212:215], v[124:127]
    v_fmac_f32 v81, v181, v10
    v_fmac_f32 v74, v178, v10
    v_mfma_f32_16x16x32_bf16 v[128:131], v[172:175], v[208:211], v[128:131]
    ds_read_b128 v[168:171], v3 offset:40960
    s_waitcnt lgkmcnt(4)
    v_mfma_f32_16x16x32_bf16 v[132:135], v[172:175], v[212:215], v[132:135]
    v_fmac_f32 v82, v182, v10
    v_fmac_f32 v75, v179, v10
    v_mfma_f32_16x16x32_bf16 v[120:123], v[152:155], v[216:219], v[120:123]
    ds_read_b128 v[172:175], v3 offset:41984
    s_waitcnt lgkmcnt(4)
    v_mfma_f32_16x16x32_bf16 v[124:127], v[152:155], v[220:223], v[124:127]
    v_fmac_f32 v83, v183, v10
    v_mul_f32 v80, v80, v11
    v_mfma_f32_16x16x32_bf16 v[128:131], v[156:159], v[216:219], v[128:131]
    ds_read_b128 v[152:155], v3 offset:55296
    s_waitcnt lgkmcnt(4)
    v_mfma_f32_16x16x32_bf16 v[132:135], v[156:159], v[220:223], v[132:135]
    v_mul_f32 v81, v81, v11
    v_mul_f32 v82, v82, v11
    v_mfma_f32_16x16x32_bf16 v[120:123], v[160:163], v[224:227], v[120:123]
    ds_read_b128 v[156:159], v3 offset:56320
    s_waitcnt lgkmcnt(4)
    v_mfma_f32_16x16x32_bf16 v[124:127], v[160:163], v[228:231], v[124:127]
    v_mul_f32 v83, v83, v11
    v_mul_f32 v80, v80, v72
    v_mfma_f32_16x16x32_bf16 v[128:131], v[164:167], v[224:227], v[128:131]
    ds_read_b128 v[160:163], v4 offset:4096
    s_waitcnt lgkmcnt(4)
    v_mfma_f32_16x16x32_bf16 v[132:135], v[164:167], v[228:231], v[132:135]
    v_mul_f32 v81, v81, v73
    v_mul_f32 v82, v82, v74
    v_mfma_f32_16x16x32_bf16 v[120:123], v[168:171], v[232:235], v[120:123]
    ds_read_b128 v[164:167], v4 offset:5120
    s_waitcnt lgkmcnt(4)
    v_mfma_f32_16x16x32_bf16 v[124:127], v[168:171], v[236:239], v[124:127]
    v_mul_f32 v83, v83, v75
    v_cvt_pk_bf16_f32 v72, v80, v81
    v_mfma_f32_16x16x32_bf16 v[128:131], v[172:175], v[232:235], v[128:131]
    ds_read_b128 v[168:171], v3 offset:0
    s_waitcnt lgkmcnt(4)
    v_mfma_f32_16x16x32_bf16 v[132:135], v[172:175], v[236:239], v[132:135]
    v_cvt_pk_bf16_f32 v73, v82, v83
    v_fmac_f32 v76, v176, v14
    v_mfma_f32_16x16x32_bf16 v[120:123], v[152:155], v[240:243], v[120:123]
    ds_read_b128 v[172:175], v3 offset:1024
    s_waitcnt lgkmcnt(4)
    v_mfma_f32_16x16x32_bf16 v[124:127], v[152:155], v[244:247], v[124:127]
    v_fmac_f32 v84, v180, v14
    v_fmac_f32 v77, v177, v14
    v_mfma_f32_16x16x32_bf16 v[128:131], v[156:159], v[240:243], v[128:131]
    ds_read_b128 v[152:155], v3 offset:14336
    s_waitcnt lgkmcnt(4)
    v_mfma_f32_16x16x32_bf16 v[132:135], v[156:159], v[244:247], v[132:135]
    v_fmac_f32 v85, v181, v14
    v_fmac_f32 v78, v178, v14
    v_mfma_f32_16x16x32_bf16 v[120:123], v[160:163], v[248:251], v[120:123]
    ds_read_b128 v[156:159], v3 offset:15360
    s_waitcnt lgkmcnt(4)
    v_mfma_f32_16x16x32_bf16 v[124:127], v[160:163], v[252:255], v[124:127]
    v_fmac_f32 v86, v182, v14
    v_fmac_f32 v79, v179, v14
    v_mfma_f32_16x16x32_bf16 v[128:131], v[164:167], v[248:251], v[128:131]
    ds_read_b128 v[160:163], v3 offset:28672
    s_waitcnt lgkmcnt(4)
    v_mfma_f32_16x16x32_bf16 v[132:135], v[164:167], v[252:255], v[132:135]
    v_fmac_f32 v87, v183, v14
    v_mul_f32 v84, v84, v15
    v_mfma_f32_16x16x32_bf16 v[136:139], v[168:171], v[208:211], v[136:139]
    ds_read_b128 v[164:167], v3 offset:29696
    s_waitcnt lgkmcnt(4)
    v_mfma_f32_16x16x32_bf16 v[140:143], v[168:171], v[212:215], v[140:143]
    v_mul_f32 v85, v85, v15
    v_mul_f32 v86, v86, v15
    v_mfma_f32_16x16x32_bf16 v[144:147], v[172:175], v[208:211], v[144:147]
    ds_read_b128 v[168:171], v3 offset:43008
    s_waitcnt lgkmcnt(4)
    v_mfma_f32_16x16x32_bf16 v[148:151], v[172:175], v[212:215], v[148:151]
    v_mul_f32 v87, v87, v15
    v_mul_f32 v84, v84, v76
    v_mfma_f32_16x16x32_bf16 v[136:139], v[152:155], v[216:219], v[136:139]
    ds_read_b128 v[172:175], v3 offset:44032
    s_waitcnt lgkmcnt(4)
    v_mfma_f32_16x16x32_bf16 v[140:143], v[152:155], v[220:223], v[140:143]
    v_mul_f32 v85, v85, v77
    v_mul_f32 v86, v86, v78
    v_mfma_f32_16x16x32_bf16 v[144:147], v[156:159], v[216:219], v[144:147]
    ds_read_b128 v[152:155], v3 offset:57344
    s_waitcnt lgkmcnt(4)
    v_mfma_f32_16x16x32_bf16 v[148:151], v[156:159], v[220:223], v[148:151]
    v_mul_f32 v87, v87, v79
    v_cvt_pk_bf16_f32 v76, v84, v85
    v_mfma_f32_16x16x32_bf16 v[136:139], v[160:163], v[224:227], v[136:139]
    ds_read_b128 v[156:159], v3 offset:58368
    s_waitcnt lgkmcnt(4)
    v_mfma_f32_16x16x32_bf16 v[140:143], v[160:163], v[228:231], v[140:143]
    v_cvt_pk_bf16_f32 v77, v86, v87
    ds_read_b128 v[176:179], v12 offset:256
    v_mfma_f32_16x16x32_bf16 v[144:147], v[164:167], v[224:227], v[144:147]
    ds_read_b128 v[160:163], v4 offset:6144
    s_waitcnt lgkmcnt(5)
    v_mfma_f32_16x16x32_bf16 v[148:151], v[164:167], v[228:231], v[148:151]
    ds_read_b128 v[180:183], v12 offset:768
    v_mfma_f32_16x16x32_bf16 v[136:139], v[168:171], v[232:235], v[136:139]
    ds_read_b128 v[164:167], v4 offset:7168
    s_waitcnt lgkmcnt(6)
    v_mfma_f32_16x16x32_bf16 v[140:143], v[168:171], v[236:239], v[140:143]
    s_cmp_lg_u32 s41, 0
    s_cbranch_scc1 L_l0_68
    s_add_u32 m0, s42, 24576
    s_add_u32 s43, s77, 24576
    buffer_load_dwordx4 v2, s[4:7], s43 offen sc1 lds
    buffer_load_dwordx4 v2, s[4:7], s43 offen offset:1024 sc1 lds
L_l0_68:
    v_mfma_f32_16x16x32_bf16 v[144:147], v[172:175], v[232:235], v[144:147]
    s_waitcnt lgkmcnt(5)
    v_mfma_f32_16x16x32_bf16 v[148:151], v[172:175], v[236:239], v[148:151]
    v_fmac_f32 v88, v184, v10
    v_mfma_f32_16x16x32_bf16 v[136:139], v[152:155], v[240:243], v[136:139]
    s_waitcnt lgkmcnt(4)
    v_mfma_f32_16x16x32_bf16 v[140:143], v[152:155], v[244:247], v[140:143]
    v_fmac_f32 v96, v188, v10
    v_fmac_f32 v89, v185, v10
    v_mfma_f32_16x16x32_bf16 v[144:147], v[156:159], v[240:243], v[144:147]
    s_waitcnt lgkmcnt(2)
    v_mfma_f32_16x16x32_bf16 v[148:151], v[156:159], v[244:247], v[148:151]
    v_fmac_f32 v97, v189, v10
    v_fmac_f32 v90, v186, v10
    v_mfma_f32_16x16x32_bf16 v[136:139], v[160:163], v[248:251], v[136:139]
    s_waitcnt lgkmcnt(0)
    v_mfma_f32_16x16x32_bf16 v[140:143], v[160:163], v[252:255], v[140:143]
    v_fmac_f32 v98, v190, v10
    v_fmac_f32 v91, v187, v10
    v_mfma_f32_16x16x32_bf16 v[144:147], v[164:167], v[248:251], v[144:147]
    v_fmac_f32 v99, v191, v10
    v_mul_f32 v96, v96, v11
    v_mfma_f32_16x16x32_bf16 v[148:151], v[164:167], v[252:255], v[148:151]
    v_mul_f32 v97, v97, v11
    v_mul_f32 v98, v98, v11
    v_mul_f32 v99, v99, v11
    v_mul_f32 v96, v96, v88
    v_mul_f32 v97, v97, v89
    v_mul_f32 v98, v98, v90
    v_mul_f32 v99, v99, v91
    v_cvt_pk_bf16_f32 v74, v96, v97
    v_cvt_pk_bf16_f32 v75, v98, v99
    buffer_store_dwordx4 v[72:75], v1, s[4:7], s54 offen offset:1024 sc1
    v_fmac_f32 v92, v184, v14
    v_fmac_f32 v100, v188, v14
    v_fmac_f32 v93, v185, v14
    v_fmac_f32 v101, v189, v14
    v_fmac_f32 v94, v186, v14
    v_fmac_f32 v102, v190, v14
    v_fmac_f32 v95, v187, v14
    v_fmac_f32 v103, v191, v14
    v_mul_f32 v100, v100, v15
    v_mul_f32 v101, v101, v15
    v_mul_f32 v102, v102, v15
    v_mul_f32 v103, v103, v15
    v_mul_f32 v100, v100, v92
    v_mul_f32 v101, v101, v93
    v_mul_f32 v102, v102, v94
    v_mul_f32 v103, v103, v95
    v_cvt_pk_bf16_f32 v78, v100, v101
    v_cvt_pk_bf16_f32 v79, v102, v103
    buffer_store_dwordx4 v[76:79], v1, s[4:7], s55 offen offset:1024 sc1
    ds_read_b128 v[184:187], v12 offset:320
    ds_read_b128 v[188:191], v12 offset:832
    s_cmp_lg_u32 s41, 0
    s_cbranch_scc1 L_l0_69
    s_add_u32 m0, s42, 32768
    s_add_u32 s43, s77, 32768
    buffer_load_dwordx4 v2, s[4:7], s43 offen sc1 lds
    buffer_load_dwordx4 v2, s[4:7], s43 offen offset:1024 sc1 lds
L_l0_69:
    v_fmac_f32 v104, v176, v10
    v_fmac_f32 v112, v180, v10
    v_fmac_f32 v105, v177, v10
    v_fmac_f32 v113, v181, v10
    v_fmac_f32 v106, v178, v10
    v_fmac_f32 v114, v182, v10
    v_fmac_f32 v107, v179, v10
    v_fmac_f32 v115, v183, v10
    v_mul_f32 v112, v112, v11
    v_mul_f32 v113, v113, v11
    v_mul_f32 v114, v114, v11
    v_mul_f32 v115, v115, v11
    v_mul_f32 v112, v112, v104
    v_mul_f32 v113, v113, v105
    v_mul_f32 v114, v114, v106
    v_mul_f32 v115, v115, v107
    v_cvt_pk_bf16_f32 v104, v112, v113
    v_cvt_pk_bf16_f32 v105, v114, v115
    v_fmac_f32 v108, v176, v14
    v_fmac_f32 v116, v180, v14
    v_fmac_f32 v109, v177, v14
    v_fmac_f32 v117, v181, v14
    v_fmac_f32 v110, v178, v14
    v_fmac_f32 v118, v182, v14
    v_fmac_f32 v111, v179, v14
    v_fmac_f32 v119, v183, v14
    v_mul_f32 v116, v116, v15
    v_mul_f32 v117, v117, v15
    v_mul_f32 v118, v118, v15
    v_mul_f32 v119, v119, v15
    v_mul_f32 v116, v116, v108
    v_mul_f32 v117, v117, v109
    v_mul_f32 v118, v118, v110
    v_mul_f32 v119, v119, v111
    v_cvt_pk_bf16_f32 v108, v116, v117
    v_cvt_pk_bf16_f32 v109, v118, v119
    ds_read_b128 v[176:179], v12 offset:384
    ds_read_b128 v[180:183], v12 offset:896
    s_waitcnt lgkmcnt(2)
    v_fmac_f32 v120, v184, v10
    v_fmac_f32 v128, v188, v10
    v_fmac_f32 v121, v185, v10
    v_fmac_f32 v129, v189, v10
    v_fmac_f32 v122, v186, v10
    v_fmac_f32 v130, v190, v10
    v_fmac_f32 v123, v187, v10
    v_fmac_f32 v131, v191, v10
    v_mul_f32 v128, v128, v11
    v_mul_f32 v129, v129, v11
    v_mul_f32 v130, v130, v11
    v_mul_f32 v131, v131, v11
    v_mul_f32 v128, v128, v120
    v_mul_f32 v129, v129, v121
    v_mul_f32 v130, v130, v122
    v_mul_f32 v131, v131, v123
    v_cvt_pk_bf16_f32 v106, v128, v129
    v_cvt_pk_bf16_f32 v107, v130, v131
    buffer_store_dwordx4 v[104:107], v1, s[4:7], s54 offen offset:2048 sc1
    v_fmac_f32 v124, v184, v14
    v_fmac_f32 v132, v188, v14
    v_fmac_f32 v125, v185, v14
    v_fmac_f32 v133, v189, v14
    v_fmac_f32 v126, v186, v14
    v_fmac_f32 v134, v190, v14
    v_fmac_f32 v127, v187, v14
    v_fmac_f32 v135, v191, v14
    v_mul_f32 v132, v132, v15
    v_mul_f32 v133, v133, v15
    v_mul_f32 v134, v134, v15
    v_mul_f32 v135, v135, v15
    v_mul_f32 v132, v132, v124
    v_mul_f32 v133, v133, v125
    v_mul_f32 v134, v134, v126
    v_mul_f32 v135, v135, v127
    v_cvt_pk_bf16_f32 v110, v132, v133
    v_cvt_pk_bf16_f32 v111, v134, v135
    buffer_store_dwordx4 v[108:111], v1, s[4:7], s55 offen offset:2048 sc1
    s_waitcnt lgkmcnt(0)
    v_fmac_f32 v136, v176, v10
    v_fmac_f32 v144, v180, v10
    v_fmac_f32 v137, v177, v10
    v_fmac_f32 v145, v181, v10
    v_fmac_f32 v138, v178, v10
    v_fmac_f32 v146, v182, v10
    v_fmac_f32 v139, v179, v10
    v_fmac_f32 v147, v183, v10
    v_mul_f32 v144, v144, v11
    v_mul_f32 v145, v145, v11
    v_mul_f32 v146, v146, v11
    v_mul_f32 v147, v147, v11
    v_mul_f32 v144, v144, v136
    v_mul_f32 v145, v145, v137
    v_mul_f32 v146, v146, v138
    v_mul_f32 v147, v147, v139
    v_cvt_pk_bf16_f32 v136, v144, v145
    v_cvt_pk_bf16_f32 v137, v146, v147
    v_fmac_f32 v140, v176, v14
    v_fmac_f32 v148, v180, v14
    v_fmac_f32 v141, v177, v14
    v_fmac_f32 v149, v181, v14
    v_fmac_f32 v142, v178, v14
    v_fmac_f32 v150, v182, v14
    v_fmac_f32 v143, v179, v14
    v_fmac_f32 v151, v183, v14
    v_mul_f32 v148, v148, v15
    v_mul_f32 v149, v149, v15
    v_mul_f32 v150, v150, v15
    v_mul_f32 v151, v151, v15
    v_mul_f32 v148, v148, v140
    v_mul_f32 v149, v149, v141
    v_mul_f32 v150, v150, v142
    v_mul_f32 v151, v151, v143
    v_cvt_pk_bf16_f32 v138, v148, v149
    v_cvt_pk_bf16_f32 v139, v150, v151
    s_nop 0
    v_permlane16_swap_b32 v136, v138
    v_permlane16_swap_b32 v137, v139
    buffer_store_dwordx4 v[136:139], v13, s[4:7], s98 offen sc1
    buffer_load_dwordx4 a[92:95], v1, s[4:7], s62 offen offset:2048 sc1
    buffer_load_dwordx4 a[96:99], v1, s[4:7], s62 offen offset:3072 sc1
    s_add_u32 s45, s45, 16
    s_waitcnt vmcnt(0) lgkmcnt(0)
    s_barrier
    s_cmp_lg_u32 s18, 0
    s_cbranch_scc1 L_noarr_70
    v_mov_b32 v19, 1
    s_mov_b64 exec, 1
    buffer_atomic_add v19, v5, s[4:7], 0 offen sc1
    s_mov_b64 exec, -1
L_noarr_70:
    s_add_u32 s62, s70, 65536
    buffer_load_dwordx4 v[192:195], v1, s[4:7], s62 offen offset:0 sc1
    buffer_load_dwordx4 v[196:199], v1, s[4:7], s62 offen offset:1024 sc1
    buffer_load_dwordx4 v[200:203], v1, s[4:7], s62 offen offset:2048 sc1
    buffer_load_dwordx4 v[204:207], v1, s[4:7], s62 offen offset:3072 sc1
    s_add_u32 s62, s70, 69632
    buffer_load_dwordx4 v[208:211], v1, s[4:7], s62 offen offset:0 sc1
    buffer_load_dwordx4 v[212:215], v1, s[4:7], s62 offen offset:1024 sc1
    s_cmp_lg_u32 s41, 0
    s_cbranch_scc1 L_l0_71
    s_add_u32 m0, s42, 40960
    s_add_u32 s43, s77, 40960
    buffer_load_dwordx4 v2, s[4:7], s43 offen sc1 lds
    buffer_load_dwordx4 v2, s[4:7], s43 offen offset:1024 sc1 lds
    s_add_u32 m0, s42, 49152
    s_add_u32 s43, s77, 49152
    buffer_load_dwordx4 v2, s[4:7], s43 offen sc1 lds
    buffer_load_dwordx4 v2, s[4:7], s43 offen offset:1024 sc1 lds
    s_add_u32 m0, s42, 57344
    s_add_u32 s43, s77, 57344
    buffer_load_dwordx4 v2, s[4:7], s43 offen sc1 lds
    buffer_load_dwordx4 v2, s[4:7], s43 offen offset:1024 sc1 lds
    s_add_u32 m0, s42, 65536
    s_add_u32 s43, s77, 65536
    buffer_load_dwordx4 v2, s[4:7], s43 offen sc1 lds
    buffer_load_dwordx4 v2, s[4:7], s43 offen offset:1024 sc1 lds
L_l0_71:
    s_mul_i32 s56, s41, 7077888
    s_sub_u32 s3, s71, s18
    s_mul_i32 s3, s3, 55296
    s_add_u32 s56, s56, s3
    s_add_u32 s56, s56, s73
    s_add_u32 s56, s56, 29220864
    s_add_u32 s3, s18, 1
    s_and_b32 s3, s3, 3
    s_mul_i32 s58, s3, 55296
    s_add_u32 s58, s58, s56
    s_mul_i32 s3, s3, 15360
    s_add_u32 s3, s3, 98304
    v_add_u32 v10, s3, v1
    s_add_u32 s3, s18, 2
    s_and_b32 s3, s3, 3
    s_mul_i32 s59, s3, 55296
    s_add_u32 s59, s59, s56
    s_mul_i32 s3, s3, 15360
    s_add_u32 s3, s3, 103424
    v_add_u32 v11, s3, v1
    s_add_u32 s3, s18, 3
    s_and_b32 s3, s3, 3
    s_mul_i32 s60, s3, 55296
    s_add_u32 s60, s60, s56
    s_mul_i32 s3, s3, 15360
    s_add_u32 s3, s3, 108544
    v_add_u32 v12, s3, v1
    s_add_u32 s3, s18, 4
    s_and_b32 s3, s3, 3
    s_mul_i32 s61, s3, 55296
    s_add_u32 s61, s61, s56
    s_mul_i32 s3, s3, 15360
    s_add_u32 s3, s3, 98304
    v_add_u32 v13, s3, v1
    s_cmp_lg_u32 s18, 0
    s_cbranch_scc1 L_nopoll_72
    s_mov_b64 exec, 1
    s_mov_b32 s47, 0
L_poll_73:
    buffer_load_dword v19, v5, s[4:7], 0 offen sc1
    s_add_u32 s47, s47, 1
    s_cmp_gt_u32 s47, 0x40000
    s_cbranch_scc1 L_pollout_74
    s_waitcnt vmcnt(0)
    v_cmp_gt_u32 vcc, s45, v19
    s_nop 0
    s_cbranch_vccnz L_poll_73
L_pollout_74:
    s_mov_b64 exec, -1
L_nopoll_72:
    s_barrier
    buffer_load_dwordx4 v[40:43], v1, s[4:7], s58 offen offset:0 sc1
    buffer_load_dwordx4 v[44:47], v1, s[4:7], s58 offen offset:1024 sc1
    buffer_load_dwordx4 v[48:51], v1, s[4:7], s58 offen offset:2048 sc1
    buffer_load_dwordx4 v[52:55], v1, s[4:7], s58 offen offset:3072 sc1
    s_add_u32 s58, s58, 4096
    buffer_load_dwordx4 v[56:59], v1, s[4:7], s58 offen offset:0 sc1
    buffer_load_dwordx4 v[60:63], v1, s[4:7], s58 offen offset:1024 sc1
    buffer_load_dwordx4 v[64:67], v1, s[4:7], s58 offen offset:2048 sc1
    buffer_load_dwordx4 v[68:71], v1, s[4:7], s58 offen offset:3072 sc1
    s_add_u32 s58, s58, 4096
    buffer_load_dwordx4 v[72:75], v1, s[4:7], s58 offen offset:0 sc1
    buffer_load_dwordx4 v[76:79], v1, s[4:7], s58 offen offset:1024 sc1
    s_waitcnt vmcnt(9)
    v_mfma_f32_16x16x32_bf16 v[152:155], a[176:179], v[40:43], 0
    buffer_load_dwordx4 v[80:83], v1, s[4:7], s58 offen offset:2048 sc1
    v_mfma_f32_16x16x32_bf16 v[156:159], a[180:183], v[40:43], 0
    buffer_load_dwordx4 v[84:87], v1, s[4:7], s58 offen offset:3072 sc1
    v_mfma_f32_16x16x32_bf16 v[160:163], a[184:187], v[40:43], 0
    v_mfma_f32_16x16x32_bf16 v[164:167], a[188:191], v[40:43], 0
    v_mfma_f32_16x16x32_bf16 v[168:171], a[192:195], v[40:43], 0
    s_waitcnt vmcnt(10)
    v_mfma_f32_16x16x32_bf16 v[152:155], a[196:199], v[44:47], v[152:155]
    s_add_u32 s58, s58, 4096
    v_mfma_f32_16x16x32_bf16 v[156:159], a[200:203], v[44:47], v[156:159]
    buffer_load_dwordx4 v[88:91], v1, s[4:7], s58 offen offset:0 sc1
    v_mfma_f32_16x16x32_bf16 v[160:163], a[204:207], v[44:47], v[160:163]
    v_mfma_f32_16x16x32_bf16 v[164:167], a[208:211], v[44:47], v[164:167]
    v_mfma_f32_16x16x32_bf16 v[168:171], a[212:215], v[44:47], v[168:171]
    s_waitcnt vmcnt(10)
    v_mfma_f32_16x16x32_bf16 v[152:155], a[216:219], v[48:51], v[152:155]
    s_add_u32 s58, s58, s94
    v_mfma_f32_16x16x32_bf16 v[156:159], a[220:223], v[48:51], v[156:159]
    buffer_load_dwordx4 v[92:95], v1, s[4:7], s58 offen offset:0 sc1
    v_mfma_f32_16x16x32_bf16 v[160:163], a[224:227], v[48:51], v[160:163]
    v_mfma_f32_16x16x32_bf16 v[164:167], a[228:231], v[48:51], v[164:167]
    v_mfma_f32_16x16x32_bf16 v[168:171], a[232:235], v[48:51], v[168:171]
    s_waitcnt vmcnt(10)
    v_mfma_f32_16x16x32_bf16 v[152:155], a[236:239], v[52:55], v[152:155]
    buffer_load_dwordx4 v[96:99], v1, s[4:7], s59 offen offset:0 sc1
    v_mfma_f32_16x16x32_bf16 v[156:159], a[240:243], v[52:55], v[156:159]
    buffer_load_dwordx4 v[100:103], v1, s[4:7], s59 offen offset:1024 sc1
    v_mfma_f32_16x16x32_bf16 v[160:163], a[244:247], v[52:55], v[160:163]
    v_mfma_f32_16x16x32_bf16 v[164:167], a[248:251], v[52:55], v[164:167]
    v_mfma_f32_16x16x32_bf16 v[168:171], a[252:255], v[52:55], v[168:171]
    s_waitcnt vmcnt(11)
    v_mfma_f32_16x16x32_bf16 v[152:155], a[100:103], v[56:59], v[152:155]
    buffer_load_dwordx4 v[104:107], v1, s[4:7], s59 offen offset:2048 sc1
    v_mfma_f32_16x16x32_bf16 v[156:159], a[104:107], v[56:59], v[156:159]
    v_mfma_f32_16x16x32_bf16 v[160:163], a[108:111], v[56:59], v[160:163]
    v_mfma_f32_16x16x32_bf16 v[164:167], a[112:115], v[56:59], v[164:167]
    v_mfma_f32_16x16x32_bf16 v[168:171], a[116:119], v[56:59], v[168:171]
    s_waitcnt vmcnt(11)
    v_mfma_f32_16x16x32_bf16 v[152:155], a[120:123], v[60:63], v[152:155]
    buffer_load_dwordx4 v[108:111], v1, s[4:7], s59 offen offset:3072 sc1
    v_mfma_f32_16x16x32_bf16 v[156:159], a[124:127], v[60:63], v[156:159]
    v_mfma_f32_16x16x32_bf16 v[160:163], a[128:131], v[60:63], v[160:163]
    v_mfma_f32_16x16x32_bf16 v[164:167], a[132:135], v[60:63], v[164:167]
    v_mfma_f32_16x16x32_bf16 v[168:171], a[136:139], v[60:63], v[168:171]
    s_waitcnt vmcnt(11)
    v_mfma_f32_16x16x32_bf16 v[152:155], a[140:143], v[64:67], v[152:155]
    s_add_u32 s59, s59, 4096
    v_mfma_f32_16x16x32_bf16 v[156:159], a[144:147], v[64:67], v[156:159]
    buffer_load_dwordx4 v[112:115], v1, s[4:7], s59 offen offset:0 sc1
    v_mfma_f32_16x16x32_bf16 v[160:163], a[148:151], v[64:67], v[160:163]
    buffer_load_dwordx4 v[116:119], v1, s[4:7], s59 offen offset:1024 sc1
    v_mfma_f32_16x16x32_bf16 v[164:167], a[152:155], v[64:67], v[164:167]
    v_mfma_f32_16x16x32_bf16 v[168:171], a[156:159], v[64:67], v[168:171]
    s_waitcnt vmcnt(12)
    v_mfma_f32_16x16x32_bf16 v[152:155], a[160:163], v[68:71], v[152:155]
    buffer_load_dwordx4 v[120:123], v1, s[4:7], s59 offen offset:2048 sc1
    v_mfma_f32_16x16x32_bf16 v[156:159], a[164:167], v[68:71], v[156:159]
    v_mfma_f32_16x16x32_bf16 v[160:163], a[168:171], v[68:71], v[160:163]
    v_mfma_f32_16x16x32_bf16 v[164:167], a[172:175], v[68:71], v[164:167]
    v_mfma_f32_16x16x32_bf16 v[168:171], a[0:3], v[68:71], v[168:171]
    s_waitcnt vmcnt(12)
    v_mfma_f32_16x16x32_bf16 v[152:155], a[4:7], v[72:75], v[152:155]
    buffer_load_dwordx4 v[124:127], v1, s[4:7], s59 offen offset:3072 sc1
    v_mfma_f32_16x16x32_bf16 v[156:159], a[8:11], v[72:75], v[156:159]
    v_mfma_f32_16x16x32_bf16 v[160:163], a[12:15], v[72:75], v[160:163]
    v_mfma_f32_16x16x32_bf16 v[164:167], a[16:19], v[72:75], v[164:167]
    v_mfma_f32_16x16x32_bf16 v[168:171], a[20:23], v[72:75], v[168:171]
    s_waitcnt vmcnt(12)
    v_mfma_f32_16x16x32_bf16 v[152:155], a[24:27], v[76:79], v[152:155]
    s_add_u32 s59, s59, 4096
    v_mfma_f32_16x16x32_bf16 v[156:159], a[28:31], v[76:79], v[156:159]
    buffer_load_dwordx4 v[128:131], v1, s[4:7], s59 offen offset:0 sc1
    v_mfma_f32_16x16x32_bf16 v[160:163], a[32:35], v[76:79], v[160:163]
    buffer_load_dwordx4 v[132:135], v1, s[4:7], s59 offen offset:1024 sc1
    v_mfma_f32_16x16x32_bf16 v[164:167], a[36:39], v[76:79], v[164:167]
    v_mfma_f32_16x16x32_bf16 v[168:171], a[40:43], v[76:79], v[168:171]
    s_waitcnt vmcnt(13)
    v_mfma_f32_16x16x32_bf16 v[152:155], a[44:47], v[80:83], v[152:155]
    buffer_load_dwordx4 v[136:139], v1, s[4:7], s59 offen offset:2048 sc1
    v_mfma_f32_16x16x32_bf16 v[156:159], a[48:51], v[80:83], v[156:159]
    v_mfma_f32_16x16x32_bf16 v[160:163], a[52:55], v[80:83], v[160:163]
    v_mfma_f32_16x16x32_bf16 v[164:167], a[56:59], v[80:83], v[164:167]
    v_mfma_f32_16x16x32_bf16 v[168:171], a[60:63], v[80:83], v[168:171]
    s_waitcnt vmcnt(13)
    v_mfma_f32_16x16x32_bf16 v[152:155], a[64:67], v[84:87], v[152:155]
    buffer_load_dwordx4 v[140:143], v1, s[4:7], s59 offen offset:3072 sc1
    v_mfma_f32_16x16x32_bf16 v[156:159], a[68:71], v[84:87], v[156:159]
    v_mfma_f32_16x16x32_bf16 v[160:163], a[72:75], v[84:87], v[160:163]
    v_mfma_f32_16x16x32_bf16 v[164:167], a[76:79], v[84:87], v[164:167]
    v_mfma_f32_16x16x32_bf16 v[168:171], a[80:83], v[84:87], v[168:171]
    s_waitcnt vmcnt(13)
    v_mfma_f32_16x16x32_bf16 v[152:155], a[84:87], v[88:91], v[152:155]
    s_add_u32 s59, s59, 4096
    v_mfma_f32_16x16x32_bf16 v[156:159], a[88:91], v[88:91], v[156:159]
    buffer_load_dwordx4 v[144:147], v1, s[4:7], s59 offen offset:0 sc1
    v_mfma_f32_16x16x32_bf16 v[160:163], a[92:95], v[88:91], v[160:163]
    s_add_u32 s59, s59, s94
    v_mfma_f32_16x16x32_bf16 v[164:167], a[96:99], v[88:91], v[164:167]
    buffer_load_dwordx4 v[148:151], v1, s[4:7], s59 offen offset:0 sc1
    v_mfma_f32_16x16x32_bf16 v[168:171], v[192:195], v[88:91], v[168:171]
    s_waitcnt vmcnt(14)
    s_cmp_ge_u32 s18, 2
    s_cbranch_scc1 L_skipk_75
    v_mfma_f32_16x16x32_bf16 v[152:155], v[196:199], v[92:95], v[152:155]
    v_mfma_f32_16x16x32_bf16 v[156:159], v[200:203], v[92:95], v[156:159]
    v_mfma_f32_16x16x32_bf16 v[160:163], v[204:207], v[92:95], v[160:163]
    v_mfma_f32_16x16x32_bf16 v[164:167], v[208:211], v[92:95], v[164:167]
    v_mfma_f32_16x16x32_bf16 v[168:171], v[212:215], v[92:95], v[168:171]
L_skipk_75:
    s_waitcnt vmcnt(13)
    v_mfma_f32_16x16x32_bf16 v[172:175], a[176:179], v[96:99], 0
    buffer_load_dwordx4 v[40:43], v1, s[4:7], s60 offen offset:0 sc1
    v_mfma_f32_16x16x32_bf16 v[176:179], a[180:183], v[96:99], 0
    buffer_load_dwordx4 v[44:47], v1, s[4:7], s60 offen offset:1024 sc1
    v_mfma_f32_16x16x32_bf16 v[180:183], a[184:187], v[96:99], 0
    v_mfma_f32_16x16x32_bf16 v[184:187], a[188:191], v[96:99], 0
    v_mfma_f32_16x16x32_bf16 v[188:191], a[192:195], v[96:99], 0
    s_waitcnt vmcnt(14)
    v_mfma_f32_16x16x32_bf16 v[172:175], a[196:199], v[100:103], v[172:175]
    buffer_load_dwordx4 v[48:51], v1, s[4:7], s60 offen offset:2048 sc1
    v_mfma_f32_16x16x32_bf16 v[176:179], a[200:203], v[100:103], v[176:179]
    buffer_load_dwordx4 v[52:55], v1, s[4:7], s60 offen offset:3072 sc1
    v_mfma_f32_16x16x32_bf16 v[180:183], a[204:207], v[100:103], v[180:183]
    ds_write_b128 v10, v[152:155] offset:0
    v_mfma_f32_16x16x32_bf16 v[184:187], a[208:211], v[100:103], v[184:187]
    ds_write_b128 v10, v[156:159] offset:1024
    v_mfma_f32_16x16x32_bf16 v[188:191], a[212:215], v[100:103], v[188:191]
    s_waitcnt vmcnt(15)
    v_mfma_f32_16x16x32_bf16 v[172:175], a[216:219], v[104:107], v[172:175]
    s_add_u32 s60, s60, 4096
    v_mfma_f32_16x16x32_bf16 v[176:179], a[220:223], v[104:107], v[176:179]
    buffer_load_dwordx4 v[56:59], v1, s[4:7], s60 offen offset:0 sc1
    v_mfma_f32_16x16x32_bf16 v[180:183], a[224:227], v[104:107], v[180:183]
    ds_write_b128 v10, v[160:163] offset:2048
    v_mfma_f32_16x16x32_bf16 v[184:187], a[228:231], v[104:107], v[184:187]
    ds_write_b128 v10, v[164:167] offset:3072
    v_mfma_f32_16x16x32_bf16 v[188:191], a[232:235], v[104:107], v[188:191]
    s_waitcnt vmcnt(15)
    v_mfma_f32_16x16x32_bf16 v[172:175], a[236:239], v[108:111], v[172:175]
    buffer_load_dwordx4 v[60:63], v1, s[4:7], s60 offen offset:1024 sc1
    v_mfma_f32_16x16x32_bf16 v[176:179], a[240:243], v[108:111], v[176:179]
    ds_write_b128 v10, v[168:171] offset:4096
    v_mfma_f32_16x16x32_bf16 v[180:183], a[244:247], v[108:111], v[180:183]
    v_mfma_f32_16x16x32_bf16 v[184:187], a[248:251], v[108:111], v[184:187]
    v_mfma_f32_16x16x32_bf16 v[188:191], a[252:255], v[108:111], v[188:191]
    s_waitcnt vmcnt(15)
    v_mfma_f32_16x16x32_bf16 v[172:175], a[100:103], v[112:115], v[172:175]
    buffer_load_dwordx4 v[64:67], v1, s[4:7], s60 offen offset:2048 sc1
    v_mfma_f32_16x16x32_bf16 v[176:179], a[104:107], v[112:115], v[176:179]
    buffer_load_dwordx4 v[68:71], v1, s[4:7], s60 offen offset:3072 sc1
    v_mfma_f32_16x16x32_bf16 v[180:183], a[108:111], v[112:115], v[180:183]
    v_mfma_f32_16x16x32_bf16 v[184:187], a[112:115], v[112:115], v[184:187]
    v_mfma_f32_16x16x32_bf16 v[188:191], a[116:119], v[112:115], v[188:191]
    s_waitcnt vmcnt(16)
    v_mfma_f32_16x16x32_bf16 v[172:175], a[120:123], v[116:119], v[172:175]
    s_add_u32 s60, s60, 4096
    v_mfma_f32_16x16x32_bf16 v[176:179], a[124:127], v[116:119], v[176:179]
    buffer_load_dwordx4 v[72:75], v1, s[4:7], s60 offen offset:0 sc1
    v_mfma_f32_16x16x32_bf16 v[180:183], a[128:131], v[116:119], v[180:183]
    v_mfma_f32_16x16x32_bf16 v[184:187], a[132:135], v[116:119], v[184:187]
    v_mfma_f32_16x16x32_bf16 v[188:191], a[136:139], v[116:119], v[188:191]
    s_waitcnt vmcnt(16)
    v_mfma_f32_16x16x32_bf16 v[172:175], a[140:143], v[120:123], v[172:175]
    buffer_load_dwordx4 v[76:79], v1, s[4:7], s60 offen offset:1024 sc1
    v_mfma_f32_16x16x32_bf16 v[176:179], a[144:147], v[120:123], v[176:179]
    v_mfma_f32_16x16x32_bf16 v[180:183], a[148:151], v[120:123], v[180:183]
    v_mfma_f32_16x16x32_bf16 v[184:187], a[152:155], v[120:123], v[184:187]
    v_mfma_f32_16x16x32_bf16 v[188:191], a[156:159], v[120:123], v[188:191]
    s_waitcnt vmcnt(16)
    v_mfma_f32_16x16x32_bf16 v[172:175], a[160:163], v[124:127], v[172:175]
    buffer_load_dwordx4 v[80:83], v1, s[4:7], s60 offen offset:2048 sc1
    v_mfma_f32_16x16x32_bf16 v[176:179], a[164:167], v[124:127], v[176:179]
    buffer_load_dwordx4 v[84:87], v1, s[4:7], s60 offen offset:3072 sc1
    v_mfma_f32_16x16x32_bf16 v[180:183], a[168:171], v[124:127], v[180:183]
    v_mfma_f32_16x16x32_bf16 v[184:187], a[172:175], v[124:127], v[184:187]
    v_mfma_f32_16x16x32_bf16 v[188:191], a[0:3], v[124:127], v[188:191]
    s_waitcnt vmcnt(17)
    v_mfma_f32_16x16x32_bf16 v[172:175], a[4:7], v[128:131], v[172:175]
    s_add_u32 s60, s60, 4096
    v_mfma_f32_16x16x32_bf16 v[176:179], a[8:11], v[128:131], v[176:179]
    buffer_load_dwordx4 v[88:91], v1, s[4:7], s60 offen offset:0 sc1
    v_mfma_f32_16x16x32_bf16 v[180:183], a[12:15], v[128:131], v[180:183]
    v_mfma_f32_16x16x32_bf16 v[184:187], a[16:19], v[128:131], v[184:187]
    v_mfma_f32_16x16x32_bf16 v[188:191], a[20:23], v[128:131], v[188:191]
    s_waitcnt vmcnt(17)
    v_mfma_f32_16x16x32_bf16 v[172:175], a[24:27], v[132:135], v[172:175]
    s_add_u32 s60, s60, s94
    v_mfma_f32_16x16x32_bf16 v[176:179], a[28:31], v[132:135], v[176:179]
    buffer_load_dwordx4 v[92:95], v1, s[4:7], s60 offen offset:0 sc1
    v_mfma_f32_16x16x32_bf16 v[180:183], a[32:35], v[132:135], v[180:183]
    v_mfma_f32_16x16x32_bf16 v[184:187], a[36:39], v[132:135], v[184:187]
    v_mfma_f32_16x16x32_bf16 v[188:191], a[40:43], v[132:135], v[188:191]
    s_waitcnt vmcnt(17)
    v_mfma_f32_16x16x32_bf16 v[172:175], a[44:47], v[136:139], v[172:175]
    buffer_load_dwordx4 v[96:99], v1, s[4:7], s61 offen offset:0 sc1
    v_mfma_f32_16x16x32_bf16 v[176:179], a[48:51], v[136:139], v[176:179]
    buffer_load_dwordx4 v[100:103], v1, s[4:7], s61 offen offset:1024 sc1
    v_mfma_f32_16x16x32_bf16 v[180:183], a[52:55], v[136:139], v[180:183]
    v_mfma_f32_16x16x32_bf16 v[184:187], a[56:59], v[136:139], v[184:187]
    v_mfma_f32_16x16x32_bf16 v[188:191], a[60:63], v[136:139], v[188:191]
    s_waitcnt vmcnt(18)
    v_mfma_f32_16x16x32_bf16 v[172:175], a[64:67], v[140:143], v[172:175]
    buffer_load_dwordx4 v[104:107], v1, s[4:7], s61 offen offset:2048 sc1
    v_mfma_f32_16x16x32_bf16 v[176:179], a[68:71], v[140:143], v[176:179]
    v_mfma_f32_16x16x32_bf16 v[180:183], a[72:75], v[140:143], v[180:183]
    v_mfma_f32_16x16x32_bf16 v[184:187], a[76:79], v[140:143], v[184:187]
    v_mfma_f32_16x16x32_bf16 v[188:191], a[80:83], v[140:143], v[188:191]
    s_waitcnt vmcnt(18)
    v_mfma_f32_16x16x32_bf16 v[172:175], a[84:87], v[144:147], v[172:175]
    buffer_load_dwordx4 v[108:111], v1, s[4:7], s61 offen offset:3072 sc1
    v_mfma_f32_16x16x32_bf16 v[176:179], a[88:91], v[144:147], v[176:179]
    v_mfma_f32_16x16x32_bf16 v[180:183], a[92:95], v[144:147], v[180:183]
    v_mfma_f32_16x16x32_bf16 v[184:187], a[96:99], v[144:147], v[184:187]
    v_mfma_f32_16x16x32_bf16 v[188:191], v[192:195], v[144:147], v[188:191]
    s_waitcnt vmcnt(18)
    s_cmp_ge_u32 s18, 2
    s_cbranch_scc1 L_skipk_76
    v_mfma_f32_16x16x32_bf16 v[172:175], v[196:199], v[148:151], v[172:175]
    v_mfma_f32_16x16x32_bf16 v[176:179], v[200:203], v[148:151], v[176:179]
    v_mfma_f32_16x16x32_bf16 v[180:183], v[204:207], v[148:151], v[180:183]
    v_mfma_f32_16x16x32_bf16 v[184:187], v[208:211], v[148:151], v[184:187]
    v_mfma_f32_16x16x32_bf16 v[188:191], v[212:215], v[148:151], v[188:191]
L_skipk_76:
    s_waitcnt vmcnt(17)
    v_mfma_f32_16x16x32_bf16 v[152:155], a[176:179], v[40:43], 0
    s_add_u32 s61, s61, 4096
    v_mfma_f32_16x16x32_bf16 v[156:159], a[180:183], v[40:43], 0
    buffer_load_dwordx4 v[112:115], v1, s[4:7], s61 offen offset:0 sc1
    v_mfma_f32_16x16x32_bf16 v[160:163], a[184:187], v[40:43], 0
    buffer_load_dwordx4 v[116:119], v1, s[4:7], s61 offen offset:1024 sc1
    v_mfma_f32_16x16x32_bf16 v[164:167], a[188:191], v[40:43], 0
    buffer_load_dwordx4 v[120:123], v1, s[4:7], s61 offen offset:2048 sc1
    v_mfma_f32_16x16x32_bf16 v[168:171], a[192:195], v[40:43], 0
    s_waitcnt vmcnt(19)
    v_mfma_f32_16x16x32_bf16 v[152:155], a[196:199], v[44:47], v[152:155]
    buffer_load_dwordx4 v[124:127], v1, s[4:7], s61 offen offset:3072 sc1
    v_mfma_f32_16x16x32_bf16 v[156:159], a[200:203], v[44:47], v[156:159]
    ds_write_b128 v11, v[172:175] offset:0
    v_mfma_f32_16x16x32_bf16 v[160:163], a[204:207], v[44:47], v[160:163]
    ds_write_b128 v11, v[176:179] offset:1024
    v_mfma_f32_16x16x32_bf16 v[164:167], a[208:211], v[44:47], v[164:167]
    ds_write_b128 v11, v[180:183] offset:2048
    v_mfma_f32_16x16x32_bf16 v[168:171], a[212:215], v[44:47], v[168:171]
    s_waitcnt vmcnt(19)
    v_mfma_f32_16x16x32_bf16 v[152:155], a[216:219], v[48:51], v[152:155]
    s_add_u32 s61, s61, 4096
    v_mfma_f32_16x16x32_bf16 v[156:159], a[220:223], v[48:51], v[156:159]
    buffer_load_dwordx4 v[128:131], v1, s[4:7], s61 offen offset:0 sc1
    v_mfma_f32_16x16x32_bf16 v[160:163], a[224:227], v[48:51], v[160:163]
    buffer_load_dwordx4 v[132:135], v1, s[4:7], s61 offen offset:1024 sc1
    v_mfma_f32_16x16x32_bf16 v[164:167], a[228:231], v[48:51], v[164:167]
    ds_write_b128 v11, v[184:187] offset:3072
    v_mfma_f32_16x16x32_bf16 v[168:171], a[232:235], v[48:51], v[168:171]
    s_waitcnt vmcnt(20)
    v_mfma_f32_16x16x32_bf16 v[152:155], a[236:239], v[52:55], v[152:155]
    buffer_load_dwordx4 v[136:139], v1, s[4:7], s61 offen offset:2048 sc1
    v_mfma_f32_16x16x32_bf16 v[156:159], a[240:243], v[52:55], v[156:159]
    ds_write_b128 v11, v[188:191] offset:4096
    v_mfma_f32_16x16x32_bf16 v[160:163], a[244:247], v[52:55], v[160:163]
    v_mfma_f32_16x16x32_bf16 v[164:167], a[248:251], v[52:55], v[164:167]
    v_mfma_f32_16x16x32_bf16 v[168:171], a[252:255], v[52:55], v[168:171]
    s_waitcnt vmcnt(20)
    v_mfma_f32_16x16x32_bf16 v[152:155], a[100:103], v[56:59], v[152:155]
    buffer_load_dwordx4 v[140:143], v1, s[4:7], s61 offen offset:3072 sc1
    v_mfma_f32_16x16x32_bf16 v[156:159], a[104:107], v[56:59], v[156:159]
    v_mfma_f32_16x16x32_bf16 v[160:163], a[108:111], v[56:59], v[160:163]
    v_mfma_f32_16x16x32_bf16 v[164:167], a[112:115], v[56:59], v[164:167]
    v_mfma_f32_16x16x32_bf16 v[168:171], a[116:119], v[56:59], v[168:171]
    s_waitcnt vmcnt(20)
    v_mfma_f32_16x16x32_bf16 v[152:155], a[120:123], v[60:63], v[152:155]
    s_add_u32 s61, s61, 4096
    v_mfma_f32_16x16x32_bf16 v[156:159], a[124:127], v[60:63], v[156:159]
    buffer_load_dwordx4 v[144:147], v1, s[4:7], s61 offen offset:0 sc1
    v_mfma_f32_16x16x32_bf16 v[160:163], a[128:131], v[60:63], v[160:163]
    s_add_u32 s61, s61, s94
    v_mfma_f32_16x16x32_bf16 v[164:167], a[132:135], v[60:63], v[164:167]
    buffer_load_dwordx4 v[148:151], v1, s[4:7], s61 offen offset:0 sc1
    v_mfma_f32_16x16x32_bf16 v[168:171], a[136:139], v[60:63], v[168:171]
    s_waitcnt vmcnt(21)
    v_mfma_f32_16x16x32_bf16 v[152:155], a[140:143], v[64:67], v[152:155]
    v_mfma_f32_16x16x32_bf16 v[156:159], a[144:147], v[64:67], v[156:159]
    v_mfma_f32_16x16x32_bf16 v[160:163], a[148:151], v[64:67], v[160:163]
    v_mfma_f32_16x16x32_bf16 v[164:167], a[152:155], v[64:67], v[164:167]
    v_mfma_f32_16x16x32_bf16 v[168:171], a[156:159], v[64:67], v[168:171]
    s_waitcnt vmcnt(20)
    v_mfma_f32_16x16x32_bf16 v[152:155], a[160:163], v[68:71], v[152:155]
    v_mfma_f32_16x16x32_bf16 v[156:159], a[164:167], v[68:71], v[156:159]
    v_mfma_f32_16x16x32_bf16 v[160:163], a[168:171], v[68:71], v[160:163]
    v_mfma_f32_16x16x32_bf16 v[164:167], a[172:175], v[68:71], v[164:167]
    v_mfma_f32_16x16x32_bf16 v[168:171], a[0:3], v[68:71], v[168:171]
    s_waitcnt vmcnt(19)
    v_mfma_f32_16x16x32_bf16 v[152:155], a[4:7], v[72:75], v[152:155]
    v_mfma_f32_16x16x32_bf16 v[156:159], a[8:11], v[72:75], v[156:159]
    v_mfma_f32_16x16x32_bf16 v[160:163], a[12:15], v[72:75], v[160:163]
    v_mfma_f32_16x16x32_bf16 v[164:167], a[16:19], v[72:75], v[164:167]
    v_mfma_f32_16x16x32_bf16 v[168:171], a[20:23], v[72:75], v[168:171]
    s_waitcnt vmcnt(18)
    v_mfma_f32_16x16x32_bf16 v[152:155], a[24:27], v[76:79], v[152:155]
    v_mfma_f32_16x16x32_bf16 v[156:159], a[28:31], v[76:79], v[156:159]
    v_mfma_f32_16x16x32_bf16 v[160:163], a[32:35], v[76:79], v[160:163]
    v_mfma_f32_16x16x32_bf16 v[164:167], a[36:39], v[76:79], v[164:167]
    v_mfma_f32_16x16x32_bf16 v[168:171], a[40:43], v[76:79], v[168:171]
    s_waitcnt vmcnt(17)
    v_mfma_f32_16x16x32_bf16 v[152:155], a[44:47], v[80:83], v[152:155]
    v_mfma_f32_16x16x32_bf16 v[156:159], a[48:51], v[80:83], v[156:159]
    v_mfma_f32_16x16x32_bf16 v[160:163], a[52:55], v[80:83], v[160:163]
    v_mfma_f32_16x16x32_bf16 v[164:167], a[56:59], v[80:83], v[164:167]
    v_mfma_f32_16x16x32_bf16 v[168:171], a[60:63], v[80:83], v[168:171]
    s_waitcnt vmcnt(16)
    v_mfma_f32_16x16x32_bf16 v[152:155], a[64:67], v[84:87], v[152:155]
    v_mfma_f32_16x16x32_bf16 v[156:159], a[68:71], v[84:87], v[156:159]
    v_mfma_f32_16x16x32_bf16 v[160:163], a[72:75], v[84:87], v[160:163]
    v_mfma_f32_16x16x32_bf16 v[164:167], a[76:79], v[84:87], v[164:167]
    v_mfma_f32_16x16x32_bf16 v[168:171], a[80:83], v[84:87], v[168:171]
    s_waitcnt vmcnt(15)
    v_mfma_f32_16x16x32_bf16 v[152:155], a[84:87], v[88:91], v[152:155]
    v_mfma_f32_16x16x32_bf16 v[156:159], a[88:91], v[88:91], v[156:159]
    v_mfma_f32_16x16x32_bf16 v[160:163], a[92:95], v[88:91], v[160:163]
    v_mfma_f32_16x16x32_bf16 v[164:167], a[96:99], v[88:91], v[164:167]
    v_mfma_f32_16x16x32_bf16 v[168:171], v[192:195], v[88:91], v[168:171]
    s_waitcnt vmcnt(14)
    s_cmp_ge_u32 s18, 2
    s_cbranch_scc1 L_skipk_77
    v_mfma_f32_16x16x32_bf16 v[152:155], v[196:199], v[92:95], v[152:155]
    v_mfma_f32_16x16x32_bf16 v[156:159], v[200:203], v[92:95], v[156:159]
    v_mfma_f32_16x16x32_bf16 v[160:163], v[204:207], v[92:95], v[160:163]
    v_mfma_f32_16x16x32_bf16 v[164:167], v[208:211], v[92:95], v[164:167]
    v_mfma_f32_16x16x32_bf16 v[168:171], v[212:215], v[92:95], v[168:171]
L_skipk_77:
    s_waitcnt vmcnt(13)
    v_mfma_f32_16x16x32_bf16 v[172:175], a[176:179], v[96:99], 0
    v_mfma_f32_16x16x32_bf16 v[176:179], a[180:183], v[96:99], 0
    v_mfma_f32_16x16x32_bf16 v[180:183], a[184:187], v[96:99], 0
    v_mfma_f32_16x16x32_bf16 v[184:187], a[188:191], v[96:99], 0
    v_mfma_f32_16x16x32_bf16 v[188:191], a[192:195], v[96:99], 0
    s_waitcnt vmcnt(12)
    v_mfma_f32_16x16x32_bf16 v[172:175], a[196:199], v[100:103], v[172:175]
    ds_write_b128 v12, v[152:155] offset:0
    v_mfma_f32_16x16x32_bf16 v[176:179], a[200:203], v[100:103], v[176:179]
    ds_write_b128 v12, v[156:159] offset:1024
    v_mfma_f32_16x16x32_bf16 v[180:183], a[204:207], v[100:103], v[180:183]
    ds_write_b128 v12, v[160:163] offset:2048
    v_mfma_f32_16x16x32_bf16 v[184:187], a[208:211], v[100:103], v[184:187]
    ds_write_b128 v12, v[164:167] offset:3072
    v_mfma_f32_16x16x32_bf16 v[188:191], a[212:215], v[100:103], v[188:191]
    s_waitcnt vmcnt(11)
    v_mfma_f32_16x16x32_bf16 v[172:175], a[216:219], v[104:107], v[172:175]
    ds_write_b128 v12, v[168:171] offset:4096
    v_mfma_f32_16x16x32_bf16 v[176:179], a[220:223], v[104:107], v[176:179]
    s_waitcnt lgkmcnt(0)
    s_barrier
    v_mfma_f32_16x16x32_bf16 v[180:183], a[224:227], v[104:107], v[180:183]
    ds_read_b128 v[40:43], v13 offset:0
    ds_read_b128 v[44:47], v13 offset:1024
    v_mfma_f32_16x16x32_bf16 v[184:187], a[228:231], v[104:107], v[184:187]
    ds_read_b128 v[48:51], v13 offset:2048
    ds_read_b128 v[52:55], v13 offset:3072
    v_mfma_f32_16x16x32_bf16 v[188:191], a[232:235], v[104:107], v[188:191]
    s_waitcnt vmcnt(10)
    ds_read_b128 v[56:59], v13 offset:4096
    v_mfma_f32_16x16x32_bf16 v[172:175], a[236:239], v[108:111], v[172:175]
    ds_read_b128 v[60:63], v13 offset:5120
    ds_read_b128 v[64:67], v13 offset:6144
    v_mfma_f32_16x16x32_bf16 v[176:179], a[240:243], v[108:111], v[176:179]
    ds_read_b128 v[68:71], v13 offset:7168
    ds_read_b128 v[72:75], v13 offset:8192
    v_mfma_f32_16x16x32_bf16 v[180:183], a[244:247], v[108:111], v[180:183]
    ds_read_b128 v[76:79], v13 offset:9216
    ds_read_b128 v[80:83], v13 offset:10240
    v_mfma_f32_16x16x32_bf16 v[184:187], a[248:251], v[108:111], v[184:187]
    ds_read_b128 v[84:87], v13 offset:11264
    ds_read_b128 v[88:91], v13 offset:12288
    v_mfma_f32_16x16x32_bf16 v[188:191], a[252:255], v[108:111], v[188:191]
    s_waitcnt vmcnt(9)
    ds_read_b128 v[92:95], v13 offset:13312
    v_mfma_f32_16x16x32_bf16 v[172:175], a[100:103], v[112:115], v[172:175]
    ds_read_b128 v[96:99], v13 offset:14336
    s_waitcnt lgkmcnt(10)
    v_mfma_f32_16x16x32_bf16 v[176:179], a[104:107], v[112:115], v[176:179]
    v_add_f32 v20, v20, v40
    v_add_f32 v21, v21, v41
    v_mfma_f32_16x16x32_bf16 v[180:183], a[108:111], v[112:115], v[180:183]
    v_add_f32 v22, v22, v42
    v_add_f32 v23, v23, v43
    v_mfma_f32_16x16x32_bf16 v[184:187], a[112:115], v[112:115], v[184:187]
    v_add_f32 v24, v24, v44
    v_add_f32 v25, v25, v45
    v_mfma_f32_16x16x32_bf16 v[188:191], a[116:119], v[112:115], v[188:191]
    s_waitcnt vmcnt(8)
    v_add_f32 v26, v26, v46
    v_mfma_f32_16x16x32_bf16 v[172:175], a[120:123], v[116:119], v[172:175]
    v_add_f32 v27, v27, v47
    v_add_f32 v28, v28, v48
    v_mfma_f32_16x16x32_bf16 v[176:179], a[124:127], v[116:119], v[176:179]
    v_add_f32 v29, v29, v49
    v_add_f32 v30, v30, v50
    v_mfma_f32_16x16x32_bf16 v[180:183], a[128:131], v[116:119], v[180:183]
    v_add_f32 v31, v31, v51
    v_add_f32 v32, v32, v52
    v_mfma_f32_16x16x32_bf16 v[184:187], a[132:135], v[116:119], v[184:187]
    v_add_f32 v33, v33, v53
    v_add_f32 v34, v34, v54
    v_mfma_f32_16x16x32_bf16 v[188:191], a[136:139], v[116:119], v[188:191]
    s_waitcnt vmcnt(7)
    v_add_f32 v35, v35, v55
    v_mfma_f32_16x16x32_bf16 v[172:175], a[140:143], v[120:123], v[172:175]
    v_add_f32 v36, v36, v56
    v_add_f32 v37, v37, v57
    v_mfma_f32_16x16x32_bf16 v[176:179], a[144:147], v[120:123], v[176:179]
    v_add_f32 v38, v38, v58
    v_add_f32 v39, v39, v59
    v_mfma_f32_16x16x32_bf16 v[180:183], a[148:151], v[120:123], v[180:183]
    s_waitcnt lgkmcnt(5)
    v_add_f32 v20, v20, v60
    v_mfma_f32_16x16x32_bf16 v[184:187], a[152:155], v[120:123], v[184:187]
    v_add_f32 v21, v21, v61
    v_add_f32 v22, v22, v62
    v_mfma_f32_16x16x32_bf16 v[188:191], a[156:159], v[120:123], v[188:191]
    s_waitcnt vmcnt(6)
    v_add_f32 v23, v23, v63
    v_mfma_f32_16x16x32_bf16 v[172:175], a[160:163], v[124:127], v[172:175]
    v_add_f32 v24, v24, v64
    v_add_f32 v25, v25, v65
    v_mfma_f32_16x16x32_bf16 v[176:179], a[164:167], v[124:127], v[176:179]
    v_add_f32 v26, v26, v66
    v_add_f32 v27, v27, v67
    v_mfma_f32_16x16x32_bf16 v[180:183], a[168:171], v[124:127], v[180:183]
    v_add_f32 v28, v28, v68
    v_add_f32 v29, v29, v69
    v_mfma_f32_16x16x32_bf16 v[184:187], a[172:175], v[124:127], v[184:187]
    v_add_f32 v30, v30, v70
    v_add_f32 v31, v31, v71
    v_mfma_f32_16x16x32_bf16 v[188:191], a[0:3], v[124:127], v[188:191]
    s_waitcnt vmcnt(5)
    v_add_f32 v32, v32, v72
    v_mfma_f32_16x16x32_bf16 v[172:175], a[4:7], v[128:131], v[172:175]
    v_add_f32 v33, v33, v73
    v_add_f32 v34, v34, v74
    v_mfma_f32_16x16x32_bf16 v[176:179], a[8:11], v[128:131], v[176:179]
    v_add_f32 v35, v35, v75
    v_add_f32 v36, v36, v76
    v_mfma_f32_16x16x32_bf16 v[180:183], a[12:15], v[128:131], v[180:183]
    v_add_f32 v37, v37, v77
    v_add_f32 v38, v38, v78
    v_mfma_f32_16x16x32_bf16 v[184:187], a[16:19], v[128:131], v[184:187]
    v_add_f32 v39, v39, v79
    s_waitcnt lgkmcnt(0)
    v_mfma_f32_16x16x32_bf16 v[188:191], a[20:23], v[128:131], v[188:191]
    s_waitcnt vmcnt(4)
    v_add_f32 v20, v20, v80
    v_mfma_f32_16x16x32_bf16 v[172:175], a[24:27], v[132:135], v[172:175]
    v_add_f32 v21, v21, v81
    v_add_f32 v22, v22, v82
    v_mfma_f32_16x16x32_bf16 v[176:179], a[28:31], v[132:135], v[176:179]
    v_add_f32 v23, v23, v83
    v_add_f32 v24, v24, v84
    v_mfma_f32_16x16x32_bf16 v[180:183], a[32:35], v[132:135], v[180:183]
    v_add_f32 v25, v25, v85
    v_add_f32 v26, v26, v86
    v_mfma_f32_16x16x32_bf16 v[184:187], a[36:39], v[132:135], v[184:187]
    v_add_f32 v27, v27, v87
    v_add_f32 v28, v28, v88
    v_mfma_f32_16x16x32_bf16 v[188:191], a[40:43], v[132:135], v[188:191]
    s_waitcnt vmcnt(3)
    v_add_f32 v29, v29, v89
    v_mfma_f32_16x16x32_bf16 v[172:175], a[44:47], v[136:139], v[172:175]
    v_add_f32 v30, v30, v90
    v_add_f32 v31, v31, v91
    v_mfma_f32_16x16x32_bf16 v[176:179], a[48:51], v[136:139], v[176:179]
    v_add_f32 v32, v32, v92
    v_add_f32 v33, v33, v93
    v_mfma_f32_16x16x32_bf16 v[180:183], a[52:55], v[136:139], v[180:183]
    v_add_f32 v34, v34, v94
    v_add_f32 v35, v35, v95
    v_mfma_f32_16x16x32_bf16 v[184:187], a[56:59], v[136:139], v[184:187]
    v_add_f32 v36, v36, v96
    v_add_f32 v37, v37, v97
    v_mfma_f32_16x16x32_bf16 v[188:191], a[60:63], v[136:139], v[188:191]
    s_waitcnt vmcnt(2)
    v_add_f32 v38, v38, v98
    v_mfma_f32_16x16x32_bf16 v[172:175], a[64:67], v[140:143], v[172:175]
    v_add_f32 v39, v39, v99
    v_mfma_f32_16x16x32_bf16 v[176:179], a[68:71], v[140:143], v[176:179]
    s_cmp_lg_u32 s41, 0
    s_cbranch_scc1 L_l0_78
    s_add_u32 m0, s42, 73728
    s_add_u32 s43, s77, 73728
    buffer_load_dwordx4 v2, s[4:7], s43 offen sc1 lds
    buffer_load_dwordx4 v2, s[4:7], s43 offen offset:1024 sc1 lds
L_l0_78:
    v_mfma_f32_16x16x32_bf16 v[180:183], a[72:75], v[140:143], v[180:183]
    s_cmp_lg_u32 s41, 0
    s_cbranch_scc1 L_l0_79
    s_add_u32 m0, s42, 81920
    s_add_u32 s43, s77, 81920
    buffer_load_dwordx4 v2, s[4:7], s43 offen sc1 lds
    buffer_load_dwordx4 v2, s[4:7], s43 offen offset:1024 sc1 lds
L_l0_79:
    v_mfma_f32_16x16x32_bf16 v[184:187], a[76:79], v[140:143], v[184:187]
    s_cmp_lg_u32 s41, 0
    s_cbranch_scc1 L_l0_80
    s_add_u32 m0, s42, 90112
    s_add_u32 s43, s77, 90112
    buffer_load_dwordx4 v2, s[4:7], s43 offen sc1 lds
    buffer_load_dwordx4 v2, s[4:7], s43 offen offset:1024 sc1 lds
L_l0_80:
    v_mfma_f32_16x16x32_bf16 v[188:191], a[80:83], v[140:143], v[188:191]
    s_waitcnt vmcnt(1)
    v_mfma_f32_16x16x32_bf16 v[172:175], a[84:87], v[144:147], v[172:175]
    v_mfma_f32_16x16x32_bf16 v[176:179], a[88:91], v[144:147], v[176:179]
    v_mfma_f32_16x16x32_bf16 v[180:183], a[92:95], v[144:147], v[180:183]
    v_mfma_f32_16x16x32_bf16 v[184:187], a[96:99], v[144:147], v[184:187]
    v_mfma_f32_16x16x32_bf16 v[188:191], v[192:195], v[144:147], v[188:191]
    s_waitcnt vmcnt(0)
    s_cmp_ge_u32 s18, 2
    s_cbranch_scc1 L_skipk_81
    v_mfma_f32_16x16x32_bf16 v[172:175], v[196:199], v[148:151], v[172:175]
    v_mfma_f32_16x16x32_bf16 v[176:179], v[200:203], v[148:151], v[176:179]
    v_mfma_f32_16x16x32_bf16 v[180:183], v[204:207], v[148:151], v[180:183]
    v_mfma_f32_16x16x32_bf16 v[184:187], v[208:211], v[148:151], v[184:187]
    v_mfma_f32_16x16x32_bf16 v[188:191], v[212:215], v[148:151], v[188:191]
L_skipk_81:
    s_cmp_lg_u32 s41, 0
    s_cbranch_scc1 L_l0_82
    s_add_u32 s62, s63, 0
    buffer_load_dwordx4 a[0:3], v1, s[4:7], s62 offen offset:0 sc1
    buffer_load_dwordx4 a[4:7], v1, s[4:7], s62 offen offset:1024 sc1
    buffer_load_dwordx4 a[8:11], v1, s[4:7], s62 offen offset:2048 sc1
    buffer_load_dwordx4 a[12:15], v1, s[4:7], s62 offen offset:3072 sc1
    s_add_u32 s62, s63, 4096
    buffer_load_dwordx4 a[16:19], v1, s[4:7], s62 offen offset:0 sc1
    buffer_load_dwordx4 a[20:23], v1, s[4:7], s62 offen offset:1024 sc1
    buffer_load_dwordx4 a[24:27], v1, s[4:7], s62 offen offset:2048 sc1
    buffer_load_dwordx4 a[28:31], v1, s[4:7], s62 offen offset:3072 sc1
    s_add_u32 s62, s63, 8192
    buffer_load_dwordx4 a[32:35], v1, s[4:7], s62 offen offset:0 sc1
    buffer_load_dwordx4 a[36:39], v1, s[4:7], s62 offen offset:1024 sc1
    buffer_load_dwordx4 a[40:43], v1, s[4:7], s62 offen offset:2048 sc1
    buffer_load_dwordx4 a[44:47], v1, s[4:7], s62 offen offset:3072 sc1
    s_add_u32 s62, s63, 12288
    buffer_load_dwordx4 a[48:51], v1, s[4:7], s62 offen offset:0 sc1
    buffer_load_dwordx4 a[52:55], v1, s[4:7], s62 offen offset:1024 sc1
    buffer_load_dwordx4 a[56:59], v1, s[4:7], s62 offen offset:2048 sc1
    buffer_load_dwordx4 a[60:63], v1, s[4:7], s62 offen offset:3072 sc1
    s_add_u32 s62, s63, 16384
    buffer_load_dwordx4 a[64:67], v1, s[4:7], s62 offen offset:0 sc1
L_l0_82:
    s_nop 5
    v_pk_add_f32 v[20:21], v[20:21], v[172:173]
    v_pk_add_f32 v[22:23], v[22:23], v[174:175]
    v_pk_add_f32 v[24:25], v[24:25], v[176:177]
    v_pk_add_f32 v[26:27], v[26:27], v[178:179]
    v_pk_add_f32 v[28:29], v[28:29], v[180:181]
    v_pk_add_f32 v[30:31], v[30:31], v[182:183]
    v_pk_add_f32 v[32:33], v[32:33], v[184:185]
    v_pk_add_f32 v[34:35], v[34:35], v[186:187]
    v_pk_add_f32 v[36:37], v[36:37], v[188:189]
    v_pk_add_f32 v[38:39], v[38:39], v[190:191]
    s_cmp_eq_u32 s41, 1
    s_cbranch_scc1 L_final
    s_mov_b32 s41, 1
    s_mov_b32 s14, 43376640
    s_add_u32 s45, s45, 16
    v_cvt_pk_bf16_f32 v100, v20, v21
    v_cvt_pk_bf16_f32 v101, v22, v23
    v_cvt_pk_bf16_f32 v102, v24, v25
    v_cvt_pk_bf16_f32 v103, v26, v27
    v_cvt_pk_bf16_f32 v104, v28, v29
    v_cvt_pk_bf16_f32 v105, v30, v31
    v_cvt_pk_bf16_f32 v106, v32, v33
    v_cvt_pk_bf16_f32 v107, v34, v35
    v_cvt_pk_bf16_f32 v108, v36, v37
    v_cvt_pk_bf16_f32 v109, v38, v39
    v_mov_b32 v110, v108
    v_mov_b32 v111, v109
    s_mul_i32 s52, s44, 2621440
    s_mul_i32 s53, s71, 20480
    s_add_u32 s52, s52, s53
    s_add_u32 s52, s52, 13492224
    s_lshl_b32 s53, s19, 11
    s_add_u32 s96, s53, s52
    buffer_store_dwordx4 v[100:103], v1, s[4:7], s96 offen sc1
    buffer_store_dwordx4 v[104:107], v1, s[4:7], s96 offen offset:1024 sc1
    v_lshlrev_b32 v20, 16, v100
    v_and_b32 v21, 0xffff0000, v100
    v_lshlrev_b32 v22, 16, v101
    v_and_b32 v23, 0xffff0000, v101
    v_lshlrev_b32 v24, 16, v102
    v_and_b32 v25, 0xffff0000, v102
    v_lshlrev_b32 v26, 16, v103
    v_and_b32 v27, 0xffff0000, v103
    v_lshlrev_b32 v28, 16, v104
    v_and_b32 v29, 0xffff0000, v104
    v_lshlrev_b32 v30, 16, v105
    v_and_b32 v31, 0xffff0000, v105
    v_lshlrev_b32 v32, 16, v106
    v_and_b32 v33, 0xffff0000, v106
    v_lshlrev_b32 v34, 16, v107
    v_and_b32 v35, 0xffff0000, v107
    v_lshlrev_b32 v36, 16, v108
    v_and_b32 v37, 0xffff0000, v108
    v_lshlrev_b32 v38, 16, v109
    v_and_b32 v39, 0xffff0000, v109
    v_permlane16_swap_b32 v108, v110
    v_permlane16_swap_b32 v109, v111
    s_lshr_b32 s53, s19, 1
    s_lshl_b32 s53, s53, 10
    s_and_b32 s3, s19, 1
    s_lshl_b32 s3, s3, 9
    s_add_u32 s53, s53, s3
    s_add_u32 s53, s53, s52
    s_add_u32 s97, s53, 16384
    v_and_b32 v10, 15, v0
    v_lshrrev_b32 v11, 5, v0
    v_lshl_add_u32 v11, v11, 4, v10
    v_lshlrev_b32 v11, 4, v11
    s_mov_b32 exec_lo, 0xffff
    s_mov_b32 exec_hi, 0xffff
    buffer_store_dwordx4 v[108:111], v11, s[4:7], s97 offen sc1
    s_mov_b64 exec, -1
    v_pk_add_f32 v[12:13], v[20:21], v[22:23]
    v_pk_mul_f32 v[14:15], v[20:21], v[20:21]
    v_pk_fma_f32 v[14:15], v[22:23], v[22:23], v[14:15]
    v_pk_add_f32 v[12:13], v[12:13], v[24:25]
    v_pk_fma_f32 v[14:15], v[24:25], v[24:25], v[14:15]
    v_pk_add_f32 v[12:13], v[12:13], v[26:27]
    v_pk_fma_f32 v[14:15], v[26:27], v[26:27], v[14:15]
    v_pk_add_f32 v[12:13], v[12:13], v[28:29]
    v_pk_fma_f32 v[14:15], v[28:29], v[28:29], v[14:15]
    v_pk_add_f32 v[12:13], v[12:13], v[30:31]
    v_pk_fma_f32 v[14:15], v[30:31], v[30:31], v[14:15]
    v_pk_add_f32 v[12:13], v[12:13], v[32:33]
    v_pk_fma_f32 v[14:15], v[32:33], v[32:33], v[14:15]
    v_pk_add_f32 v[12:13], v[12:13], v[34:35]
    v_pk_fma_f32 v[14:15], v[34:35], v[34:35], v[14:15]
    v_pk_add_f32 v[12:13], v[12:13], v[36:37]
    v_pk_fma_f32 v[14:15], v[36:37], v[36:37], v[14:15]
    v_pk_add_f32 v[12:13], v[12:13], v[38:39]
    v_pk_fma_f32 v[14:15], v[38:39], v[38:39], v[14:15]
    v_add_f32 v12, v12, v13
    v_add_f32 v13, v14, v15
    v_mov_b32 v14, v12
    v_mov_b32 v15, v13
    s_nop 0
    v_permlane16_swap_b32 v12, v14
    v_permlane16_swap_b32 v13, v15
    v_add_f32 v12, v12, v14
    v_add_f32 v13, v13, v15
    v_mov_b32 v14, v12
    v_mov_b32 v15, v13
    s_nop 0
    v_permlane32_swap_b32 v12, v14
    v_permlane32_swap_b32 v13, v15
    v_add_f32 v12, v12, v14
    v_add_f32 v13, v13, v15
    s_mul_i32 s52, s44, 131072
    s_lshl_b32 s53, s71, 10
    s_add_u32 s52, s52, s53
    s_lshl_b32 s53, s19, 7
    s_add_u32 s52, s52, s53
    s_add_u32 s98, s52, 622592
    v_lshlrev_b32 v10, 3, v10
    s_mov_b64 exec, s[68:69]
    buffer_store_dwordx2 v[12:13], v10, s[4:7], s98 offen sc1
    s_mov_b64 exec, -1
    s_add_u32 s44, s44, 1
    s_waitcnt vmcnt(0) lgkmcnt(0)
    s_barrier
    s_cmp_lg_u32 s18, 0
    s_cbranch_scc1 L_noarr_83
    v_mov_b32 v19, 1
    s_mov_b64 exec, 1
    buffer_atomic_add v19, v5, s[4:7], 0 offen sc1
    s_mov_b64 exec, -1
L_noarr_83:
    s_add_u32 m0, s42, 98304
    s_add_u32 s43, s77, 98304
    buffer_load_dwordx4 v2, s[4:7], s43 offen sc1 lds
    buffer_load_dwordx4 v2, s[4:7], s43 offen offset:1024 sc1 lds
    s_sub_u32 s58, s44, 1
    s_mul_i32 s58, s58, 2621440
    s_mul_i32 s3, s72, 20480
    s_add_u32 s58, s58, s3
    s_add_u32 s58, s58, 13492224
    s_add_u32 s59, s58, 20480
    s_sub_u32 s52, s44, 1
    s_mul_i32 s52, s52, 131072
    s_lshl_b32 s53, s72, 10
    s_add_u32 s52, s52, s53
    s_add_u32 s52, s52, 622592
    v_and_b32 v112, 15, v0
    v_lshlrev_b32 v112, 3, v112
    v_and_b32 v113, 48, v0
    v_lshl_add_u32 v112, v113, 4, v112
    s_cmp_lg_u32 s18, 0
    s_cbranch_scc1 L_nopoll_84
    s_mov_b64 exec, 1
    s_mov_b32 s47, 0
L_poll_85:
    buffer_load_dword v19, v5, s[4:7], 0 offen sc1
    s_add_u32 s47, s47, 1
    s_cmp_gt_u32 s47, 0x40000
    s_cbranch_scc1 L_pollout_86
    s_waitcnt vmcnt(0)
    v_cmp_gt_u32 vcc, s45, v19
    s_nop 0
    s_cbranch_vccnz L_poll_85
L_pollout_86:
    s_mov_b64 exec, -1
L_nopoll_84:
    s_barrier
    s_nop 3
    s_branch L_k1
L_final:
    s_nop 1
    v_cvt_pk_bf16_f32 v100, v20, v21
    v_cvt_pk_bf16_f32 v101, v22, v23
    v_cvt_pk_bf16_f32 v102, v24, v25
    v_cvt_pk_bf16_f32 v103, v26, v27
    v_cvt_pk_bf16_f32 v104, v28, v29
    v_cvt_pk_bf16_f32 v105, v30, v31
    v_cvt_pk_bf16_f32 v106, v32, v33
    v_cvt_pk_bf16_f32 v107, v34, v35
    v_cvt_pk_bf16_f32 v108, v36, v37
    v_cvt_pk_bf16_f32 v109, v38, v39
    v_mov_b32 v110, v108
    v_mov_b32 v111, v109
    s_mov_b32 s8, s34
    s_and_b32 s9, s35, 0xffff
    s_mov_b32 s10, 2621440
    s_mov_b32 s11, 0x20000
    v_and_b32 v10, 15, v0
    v_mul_u32_u24 v10, 1280, v10
    v_bfe_u32 v11, v0, 4, 1
    v_lshl_add_u32 v10, v11, 5, v10
    v_lshrrev_b32 v11, 5, v0
    v_lshl_add_u32 v10, v11, 4, v10
    s_mul_i32 s52, s71, 20480
    s_mul_i32 s53, s19, 160
    s_add_u32 s52, s52, s53
    v_permlane16_swap_b32 v100, v102
    v_permlane16_swap_b32 v101, v103
    v_permlane16_swap_b32 v104, v106
    v_permlane16_swap_b32 v105, v107
    v_permlane16_swap_b32 v108, v110
    v_permlane16_swap_b32 v109, v111
    buffer_store_dwordx4 v[100:103], v10, s[8:11], s52 offen nt
    buffer_store_dwordx4 v[104:107], v10, s[8:11], s52 offen offset:64 nt
    s_mov_b32 exec_lo, 0xffff
    s_mov_b32 exec_hi, 0xffff
    buffer_store_dwordx4 v[108:111], v10, s[8:11], s52 offen offset:128 nt
    s_mov_b64 exec, -1
L_end:
    s_endpgm
.section .rodata,"a"
.p2align 6
.amdhsa_kernel interleave_layers__linear_attn_block__glu_gated_bilinear__prompt_kernel
  .amdhsa_next_free_vgpr 512
  .amdhsa_next_free_sgpr 102
  .amdhsa_accum_offset 256
  .amdhsa_group_segment_fixed_size 0
  .amdhsa_kernarg_size 80
  .amdhsa_user_sgpr_count 2
  .amdhsa_user_sgpr_kernarg_segment_ptr 1
  .amdhsa_system_sgpr_workgroup_id_x 1
  .amdhsa_float_denorm_mode_32 3
.end_amdhsa_kernel
```
